```python
import torch

def _softmax(x, axis=-1):
    return torch.softmax(x, dim=axis)
def _gelu(x):
    return torch.nn.functional.gelu(x, approximate="tanh")
def _silu(x):
    return torch.nn.functional.silu(x)
def _sigmoid(x):
    return torch.sigmoid(x)
def _layernorm(x, axis=-1, eps=1e-5):
    m = x.mean(dim=axis, keepdim=True)
    v = x.var(dim=axis, keepdim=True, unbiased=False)
    return (x - m) / torch.sqrt(v + eps)
def _scatter_add(tgt, idx, src, axis=0):
    return tgt.clone().index_add_(axis, idx, src)
def _segment_sum(src, seg, n):
    out = torch.zeros((n,) + src.shape[1:], dtype=src.dtype)
    return out.index_add_(0, seg, src)
def _pad(x, pw):
    flat = tuple(v for pair in reversed(pw) for v in pair)
    return torch.nn.functional.pad(x, flat)

kernel_name = 'sequential_preLN__ssm_conv_h3__dense_activation_mish__prompt'

def setup_inputs():

    _w = (lambda a: (lambda t: t.to(torch.bfloat16) if t.is_floating_point() else t)(torch.as_tensor(a)))
    def _A_setup():
        B, S, D = 1, 2048, 448
        ks = 4
        return {
            "q": _w((lambda *s: torch.randn(*s, dtype=torch.bfloat16) * 0.05)(B, S, D)),
            "k": _w((lambda *s: torch.randn(*s, dtype=torch.bfloat16) * 0.2)(B, S, D)),
            "v": _w((lambda *s: torch.randn(*s, dtype=torch.bfloat16) * 0.2)(B, S, D)),
            "shift_k": _w((lambda *s: torch.randn(*s, dtype=torch.bfloat16) * 0.2)(D, ks) * 0.5),
            "ssm_k": _w((lambda *s: torch.randn(*s, dtype=torch.bfloat16) * 0.8)(D, S) * (1.0 / S ** 0.5)),
            "ssm_D": _w((lambda *s: torch.randn(*s, dtype=torch.bfloat16) * 0.2)(D)),
        }
    _A_in = _A_setup()

    def _B_setup():
        B, S, D, F = 1, 2048, 448, 1792
        return {
            "x": _w((lambda *s: torch.randn(*s, dtype=torch.bfloat16) * 0.05)(B, S, D)),
            "w1": _w((lambda *s: torch.randn(*s, dtype=torch.bfloat16) * 0.8)(D, F) * (D ** -0.5)),
            "b1": _w((lambda *s: torch.randn(*s, dtype=torch.bfloat16) * 0.2)(F)),
            "w2": _w((lambda *s: torch.randn(*s, dtype=torch.bfloat16) * 0.1)(F, D) * (F ** -0.5)),
        }
    _B_in = _B_setup()

    return {
        "A_q": _A_in["q"],
        "A_k": _A_in["k"],
        "A_v": _A_in["v"],
        "A_shift_k": _A_in["shift_k"],
        "A_ssm_k": _A_in["ssm_k"],
        "A_ssm_D": _A_in["ssm_D"],
        "B_x": _B_in["x"],
        "B_w1": _B_in["w1"],
        "B_b1": _B_in["b1"],
        "B_w2": _B_in["w2"],
    }

def reference(A_q, A_k, A_v, A_shift_k, A_ssm_k, A_ssm_D, B_x, B_w1, B_b1, B_w2):
    def _A_ref(q, k, v, shift_k, ssm_k, ssm_D):
        B, S, D = q.shape
        ks = shift_k.shape[-1]
        k_pad = _pad(k, ((0, 0), (ks - 1, 0), (0, 0)))
        k_shift = torch.zeros_like(k)
        for t in range(ks):
            k_shift = k_shift + k_pad[:, t:t + S, :] * shift_k[:, ks - 1 - t][None, None, :]
        kv = k_shift * v
        L = 2 * S
        kv_pad = _pad(kv, ((0, 0), (0, S), (0, 0)))
        kf_pad = _pad(ssm_k, ((0, 0), (0, S)))
        kv_f = (lambda x, axes=(-2,-1): torch.fft.rfft2(x.float(), dim=axes))(kv_pad[:, None, :, :], axes=(1, 2))
        kf_f = (lambda x, axes=(-2,-1): torch.fft.rfft2(x.float(), dim=axes))(kf_pad[:, None, :], axes=(1, 2))
        kf_f = (lambda x, *d: x.permute(*d))(kf_f, 1, 2, 0)
        y_f = kv_f * kf_f[None, :, :, :]
        y = (lambda x, s, axes=(-2,-1): torch.fft.irfft2(x, s=s, dim=axes).to(torch.bfloat16))(y_f, (1, L), axes=(1, 2))[:, 0, :S, :]
        y = y + kv * ssm_D[None, None, :]
        return q * y

    def _B_ref(x, w1, b1, w2):
        h = torch.einsum("bsd,df->bsf", x, w1) + b1
        sp = torch.log1p(torch.exp(-torch.abs(h))) + torch.where(h > 0, h, torch.zeros_like(h))
        act = h * torch.tanh(sp)
        return torch.einsum("bsf,fd->bsd", act, w2)

    x = A_q
    h = x + _A_ref(_layernorm(x, axis=-1), A_k, A_v, A_shift_k, A_ssm_k, A_ssm_D)
    h2 = h + _B_ref(_layernorm(h, axis=-1), B_w1, B_b1, B_w2)
    return h2
```

```asm
; @launch grid=(256,1,1) block=(256,1,1) lds=159744
.amdgcn_target "amdgcn-amd-amdhsa--gfx950"
.text
.globl sequential_preLN__ssm_conv_h3__dense_activation_mish__prompt_kernel
.p2align 12
.p2align 8
.type sequential_preLN__ssm_conv_h3__dense_activation_mish__prompt_kernel,@function
sequential_preLN__ssm_conv_h3__dense_activation_mish__prompt_kernel:
  s_getpc_b64 s[94:95]
Lpc:
  v_lshlrev_b32 v11, 7, v0
  v_min_u32 v11, Lend-Lpc, v11
  global_load_dword v15, v11, s[94:95]
  s_cmp_ge_u32 s2, 256
  s_cbranch_scc1 Lend
  s_load_dwordx2 s[36:37], s[0:1], 8
  s_load_dwordx2 s[40:41], s[0:1], 16
  s_load_dwordx2 s[68:69], s[0:1], 24
  s_load_dwordx2 s[32:33], s[0:1], 0
  s_load_dwordx2 s[56:57], s[0:1], 96
  s_load_dwordx2 s[44:45], s[0:1], 32
  s_mov_b32 s38, 1835008
  s_mov_b32 s39, 0x20000
  s_mov_b32 s42, 1835008
  s_mov_b32 s43, 0x20000
  s_mov_b32 s34, 1835008
  s_mov_b32 s35, 0x20000
  s_mov_b32 s70, 3584
  s_mov_b32 s71, 0x20000
  s_mov_b32 s46, 4096
  s_mov_b32 s47, 0x20000
  s_mov_b32 s50, 1605632
  s_mov_b32 s51, 0x20000
  s_mov_b32 s66, 3584
  s_mov_b32 s67, 0x20000
  s_mov_b32 s54, 1605632
  s_mov_b32 s55, 0x20000
  s_mov_b32 s62, 1835008
  s_mov_b32 s63, 0x20000
  s_mov_b32 s58, 24117248
  s_mov_b32 s59, 0x20000
  v_lshrrev_b32 v11, 6, v0
  v_and_b32 v1, 63, v0
  v_readfirstlane_b32 s73, v11
  s_mov_b32 s79, 0xffff0000
  s_mov_b32 s80, 0x05040100
  s_mov_b32 s81, 0x07060302
  s_lshr_b32 s74, s2, 5
  s_and_b32 s75, s2, 31
  s_cmp_ge_u32 s2, 224
  s_cbranch_scc1 Lhelper
  s_lshl_b32 s85, s75, 2
  s_add_u32 s85, s85, s73
  s_mul_i32 s85, s85, 14336
  s_lshl_b32 s86, s74, 7
  s_add_u32 s85, s85, s86
  v_lshrrev_b32 v11, 3, v1
  v_and_b32 v12, 7, v1
  v_mul_u32_u24 v16, 896, v11
  v_lshl_add_u32 v16, v12, 4, v16
  v_add_u32 v16, s85, v16
  v_subrev_u32 v18, 7168, v16
  s_mul_i32 s89, s73, 24576
  s_add_u32 s89, s89, 59392
  s_mov_b32 s87, 7168
  s_add_u32 m0, s89, 1024
  s_lshl_b32 s86, s74, 9
  v_and_b32 v12, 31, v0
  v_lshl_add_u32 v19, v12, 4, s86
  s_waitcnt lgkmcnt(0)
  buffer_load_dwordx4 v16, s[36:39], 0 offen offset:0 nt lds
  s_add_u32 m0, s89, 2048
  s_load_dwordx2 s[90:91], s[0:1], 40
  s_load_dwordx2 s[48:49], s[0:1], 56
  s_load_dwordx2 s[64:65], s[0:1], 64
  s_load_dwordx2 s[52:53], s[0:1], 72
  s_load_dwordx2 s[60:61], s[0:1], 80
  buffer_load_dwordx4 v16, s[36:39], s87 offen offset:0 nt lds
  s_mov_b32 m0, s89
  s_mov_b32 exec_lo, 0
  s_mov_b32 exec_hi, 0xffffff00
  buffer_load_dwordx4 v18, s[36:39], 0 offen offset:0 nt lds
  s_mov_b64 exec, -1
  buffer_load_dwordx4 v[48:51], v19, s[68:71], 0 offen
  s_add_u32 m0, s89, 3072
  s_nop 0
  buffer_load_dwordx4 v16, s[40:43], 0 offen offset:0 nt lds
  s_add_u32 m0, s89, 4096
  s_nop 0
  buffer_load_dwordx4 v16, s[40:43], s87 offen offset:0 nt lds
  s_add_u32 m0, s89, 5120
  s_nop 0
  buffer_load_dwordx4 v16, s[32:35], 0 offen offset:0 lds
  s_add_u32 m0, s89, 6144
  s_nop 0
  buffer_load_dwordx4 v16, s[32:35], s87 offen offset:0 lds
  s_lshr_b32 s86, s73, 1
  s_lshl_b32 s85, s2, 1
  s_add_u32 s85, s85, s86
  s_lshl_b32 s85, s85, 12
  s_add_u32 s44, s44, s85
  s_addc_u32 s45, s45, 0
  s_mul_i32 s86, s86, 4224
  s_add_u32 s86, s86, 66560
  s_and_b32 s85, s73, 1
  s_lshl_b32 s85, s85, 11
  s_add_u32 s88, s86, s85
  s_add_u32 m0, s88, 32
  v_lshlrev_b32 v180, 4, v1
  buffer_load_dwordx4 v180, s[44:47], s85 offen offset:0 nt lds
  buffer_load_dwordx4 v180, s[44:47], s85 offen offset:1024 nt lds
  s_lshl_b32 s85, s2, 2
  s_waitcnt lgkmcnt(0)
  s_load_dword s72, s[56:57], 0
  s_load_dword s78, s[90:91], s85
  v_and_b32 v13, 127, v0
  v_lshl_add_u32 v182, v13, 4, s86
  v_cmp_lt_u32 vcc, 1, v1
  v_add_u32 v180, s86, v180
  v_add_u32 v181, 4096, v180
  v_cndmask_b32 v181, v180, v181, vcc
  v_mov_b32 v160, 0
  v_mov_b32 v161, 0
  v_mov_b32 v162, 0
  v_mov_b32 v163, 0
  s_mov_b64 exec, 63
  ds_write_b128 v181, v[160:163]
  s_mov_b64 exec, -1
  v_lshrrev_b32 v11, 5, v1
  v_and_b32 v12, 31, v1
  v_lshlrev_b32 v11, 10, v11
  v_lshl_add_u32 v11, v12, 2, v11
  v_add_u32 v16, s89, v11
  v_add_u32 v17, 128, v16
  s_lshr_b32 s85, s2, 3
  s_and_b32 s86, s2, 1
  s_mul_i32 s86, s86, 28
  s_add_u32 s85, s85, s86
  s_lshr_b32 s77, s85, 3
  s_and_b32 s85, s85, 7
  s_and_b32 s86, s2, 6
  s_lshl_b32 s86, s86, 2
  s_add_u32 s76, s85, s86
  s_lshl_b32 s96, s77, 9
  s_lshl_b32 s85, s73, 7
  s_add_u32 s96, s96, s85
  s_mul_i32 s97, s77, 229376
  s_add_u32 s97, s97, s85
  s_and_b32 s85, s76, 7
  s_and_b32 s86, s76, 3
  s_lshl_b32 s86, s86, 1
  s_cmp_eq_u32 s77, 3
  s_cselect_b32 s85, s86, s85
  s_cmp_eq_u32 s85, 7
  s_cselect_b32 s85, 3, s85
  s_lshl_b32 s3, s85, 2
  s_mul_i32 s85, s3, 57344
  s_add_u32 s0, s96, s85
  s_sub_u32 s1, s0, 1605632
  v_lshrrev_b32 v11, 3, v1
  v_lshrrev_b32 v12, 2, v1
  v_and_b32 v12, 4, v12
  v_and_b32 v13, 7, v1
  v_xor_b32 v12, v12, v13
  v_lshlrev_b32 v12, 4, v12
  v_mul_u32_u24 v11, 3584, v11
  v_add_u32 v6, v11, v12
  v_add_u32 v7, 27648, v6
  v_add_u32 v8, 55296, v6
  v_add_u32 v9, 82944, v6
  v_and_b32 v11, 19, v1
  v_bfe_u32 v12, v1, 2, 1
  v_lshl_or_b32 v11, v12, 3, v11
  v_bfe_u32 v12, v1, 3, 1
  v_lshl_or_b32 v11, v12, 2, v11
  v_lshlrev_b32 v11, 1, v11
  buffer_load_ushort v10, v11, s[64:67], s96 offen
  buffer_load_ushort v15, v11, s[64:67], s96 offen offset:64
  v_lshrrev_b32 v11, 5, v1
  v_bfe_u32 v12, v1, 2, 2
  v_lshl_add_u32 v11, v11, 3, v12
  v_lshlrev_b32 v11, 7, v11
  v_lshrrev_b32 v12, 1, v12
  v_lshlrev_b32 v12, 6, v12
  v_bfe_u32 v13, v1, 4, 1
  v_lshl_or_b32 v12, v13, 5, v12
  v_or_b32 v11, v11, v12
  v_and_b32 v12, 3, v1
  v_lshl_or_b32 v4, v12, 3, v11
  v_xor_b32 v5, 64, v4
  v_and_b32 v12, 1, v1
  v_lshl_or_b32 v11, v12, 4, v11
  v_bfe_u32 v12, v1, 1, 1
  v_lshl_or_b32 v11, v12, 3, v11
  v_add_u32 v2, s89, v11
  v_xor_b32 v3, 64, v2
  v_and_b32 v11, 31, v0
  v_mul_u32_u24 v11, 784, v11
  v_lshrrev_b32 v12, 5, v0
  v_lshl_add_u32 v183, v12, 4, v11
  v_lshrrev_b32 v11, 3, v0
  v_and_b32 v12, 7, v0
  v_mul_u32_u24 v13, 784, v11
  v_lshl_add_u32 v184, v12, 4, v13
  v_mul_u32_u24 v13, 24576, v11
  v_lshl_add_u32 v185, v12, 4, v13
  s_mul_i32 s85, s74, 786432
  s_mul_i32 s86, s75, 768
  s_add_u32 s85, s85, s86
  s_add_u32 s85, s85, 1048576
  v_add_u32 v185, s85, v185
  v_mov_b32 v133, 0
  v_mov_b32 v138, 0
  v_lshrrev_b32 v11, 3, v0
  v_mul_u32_u24 v11, 768, v11
  v_and_b32 v12, 7, v0
  v_lshl_add_u32 v11, v12, 4, v11
  s_mul_i32 s85, s2, 24576
  s_add_u32 s85, s85, 1048576
  v_add_u32 v250, s85, v11
  s_mov_b64 exec, 0
  s_cmp_eq_u32 s73, 0
  s_cbranch_scc1 Lpg1
  s_cmp_eq_u32 s73, 1
  s_cbranch_scc1 Lpg2
  s_cmp_eq_u32 s73, 2
  s_cbranch_scc1 Lpg3
  s_cmp_eq_u32 s73, 3
  s_cbranch_scc1 Lpg4
Lpgr_p0:
  s_mov_b64 exec, -1
  s_waitcnt vmcnt(9)
  ds_read2st64_b32 v[20:21], v17 offset0:2 offset1:3
  ds_read2st64_b32 v[22:23], v17 offset0:4 offset1:5
  ds_read2st64_b32 v[24:25], v17 offset0:6 offset1:7
  ds_read2st64_b32 v[26:27], v16 offset0:3 offset1:4
  ds_read2st64_b32 v[28:29], v16 offset0:5 offset1:6
  ds_read_b32 v30, v16 offset:1792
  s_waitcnt vmcnt(8)
  v_lshlrev_b32 v90, 16, v48
  v_lshlrev_b32 v91, 16, v50
  v_and_b32 v92, s79, v48
  v_and_b32 v93, s79, v50
  v_lshlrev_b32 v94, 16, v49
  v_lshlrev_b32 v95, 16, v51
  v_and_b32 v96, s79, v49
  v_and_b32 v97, s79, v51
  s_waitcnt lgkmcnt(0)
  v_lshlrev_b32 v52, 16, v20
  v_and_b32 v53, s79, v20
  v_lshlrev_b32 v54, 16, v26
  v_and_b32 v55, s79, v26
  v_lshlrev_b32 v56, 16, v21
  v_and_b32 v57, s79, v21
  v_lshlrev_b32 v58, 16, v27
  v_and_b32 v59, s79, v27
  v_lshlrev_b32 v60, 16, v22
  v_and_b32 v61, s79, v22
  v_lshlrev_b32 v62, 16, v28
  v_and_b32 v63, s79, v28
  v_lshlrev_b32 v64, 16, v23
  v_and_b32 v65, s79, v23
  v_lshlrev_b32 v66, 16, v29
  v_and_b32 v67, s79, v29
  v_lshlrev_b32 v68, 16, v24
  v_and_b32 v69, s79, v24
  v_lshlrev_b32 v70, 16, v30
  v_and_b32 v71, s79, v30
  v_lshlrev_b32 v72, 16, v25
  v_and_b32 v73, s79, v25
  s_waitcnt vmcnt(6)
  ds_read2st64_b32 v[32:33], v16 offset0:12 offset1:13
  ds_read2st64_b32 v[34:35], v16 offset0:14 offset1:15
  ds_read2st64_b32 v[36:37], v17 offset0:12 offset1:13
  ds_read2st64_b32 v[38:39], v17 offset0:14 offset1:15
  v_pk_mul_f32 v[98:99], v[90:91], v[58:59]
  v_pk_mul_f32 v[100:101], v[90:91], v[60:61]
  v_pk_mul_f32 v[102:103], v[90:91], v[62:63]
  v_pk_mul_f32 v[104:105], v[90:91], v[64:65]
  v_pk_mul_f32 v[106:107], v[90:91], v[66:67]
  v_pk_mul_f32 v[108:109], v[90:91], v[68:69]
  v_pk_mul_f32 v[110:111], v[90:91], v[70:71]
  v_pk_mul_f32 v[112:113], v[90:91], v[72:73]
  v_pk_fma_f32 v[98:99], v[92:93], v[56:57], v[98:99]
  v_pk_fma_f32 v[100:101], v[92:93], v[58:59], v[100:101]
  v_pk_fma_f32 v[102:103], v[92:93], v[60:61], v[102:103]
  v_pk_fma_f32 v[104:105], v[92:93], v[62:63], v[104:105]
  v_pk_fma_f32 v[106:107], v[92:93], v[64:65], v[106:107]
  v_pk_fma_f32 v[108:109], v[92:93], v[66:67], v[108:109]
  v_pk_fma_f32 v[110:111], v[92:93], v[68:69], v[110:111]
  v_pk_fma_f32 v[112:113], v[92:93], v[70:71], v[112:113]
  v_pk_fma_f32 v[98:99], v[94:95], v[54:55], v[98:99]
  v_pk_fma_f32 v[100:101], v[94:95], v[56:57], v[100:101]
  v_pk_fma_f32 v[102:103], v[94:95], v[58:59], v[102:103]
  v_pk_fma_f32 v[104:105], v[94:95], v[60:61], v[104:105]
  v_pk_fma_f32 v[106:107], v[94:95], v[62:63], v[106:107]
  v_pk_fma_f32 v[108:109], v[94:95], v[64:65], v[108:109]
  v_pk_fma_f32 v[110:111], v[94:95], v[66:67], v[110:111]
  v_pk_fma_f32 v[112:113], v[94:95], v[68:69], v[112:113]
  v_pk_fma_f32 v[98:99], v[96:97], v[52:53], v[98:99]
  v_pk_fma_f32 v[100:101], v[96:97], v[54:55], v[100:101]
  v_pk_fma_f32 v[102:103], v[96:97], v[56:57], v[102:103]
  v_pk_fma_f32 v[104:105], v[96:97], v[58:59], v[104:105]
  v_pk_fma_f32 v[106:107], v[96:97], v[60:61], v[106:107]
  v_pk_fma_f32 v[108:109], v[96:97], v[62:63], v[108:109]
  v_pk_fma_f32 v[110:111], v[96:97], v[64:65], v[110:111]
  v_pk_fma_f32 v[112:113], v[96:97], v[66:67], v[112:113]
  s_waitcnt lgkmcnt(0)
  s_add_u32 s72, s72, 2654435761
  v_mov_b32 v116, s72
  v_mov_b32 v123, s72
  v_mov_b32 v124, s72
  v_mov_b32 v131, s72
  v_mov_b32 v132, s72
  v_mov_b32 v139, s72
  v_lshlrev_b32 v74, 16, v32
  v_and_b32 v75, s79, v32
  v_lshlrev_b32 v76, 16, v36
  v_and_b32 v77, s79, v36
  v_lshlrev_b32 v78, 16, v33
  v_and_b32 v79, s79, v33
  v_lshlrev_b32 v80, 16, v37
  v_and_b32 v81, s79, v37
  v_lshlrev_b32 v82, 16, v34
  v_and_b32 v83, s79, v34
  v_lshlrev_b32 v84, 16, v38
  v_and_b32 v85, s79, v38
  v_lshlrev_b32 v86, 16, v35
  v_and_b32 v87, s79, v35
  v_lshlrev_b32 v88, 16, v39
  v_and_b32 v89, s79, v39
  s_waitcnt vmcnt(4)
  ds_read2st64_b32 v[40:41], v16 offset0:20 offset1:21
  ds_read2st64_b32 v[42:43], v16 offset0:22 offset1:23
  ds_read2st64_b32 v[44:45], v17 offset0:20 offset1:21
  ds_read2st64_b32 v[46:47], v17 offset0:22 offset1:23
  v_pk_mul_f32 v[98:99], v[98:99], v[74:75]
  v_pk_mul_f32 v[100:101], v[100:101], v[76:77]
  v_pk_mul_f32 v[102:103], v[102:103], v[78:79]
  v_pk_mul_f32 v[104:105], v[104:105], v[80:81]
  v_pk_mul_f32 v[106:107], v[106:107], v[82:83]
  v_pk_mul_f32 v[108:109], v[108:109], v[84:85]
  v_pk_mul_f32 v[110:111], v[110:111], v[86:87]
  v_pk_mul_f32 v[112:113], v[112:113], v[88:89]
  v_cvt_pk_bf16_f32 v118, v112, v110
  v_cvt_pk_bf16_f32 v119, v108, v106
  v_cvt_pk_bf16_f32 v120, v104, v102
  v_cvt_pk_bf16_f32 v121, v100, v98
  v_cvt_pk_bf16_f32 v126, v113, v111
  v_cvt_pk_bf16_f32 v127, v109, v107
  v_cvt_pk_bf16_f32 v128, v105, v103
  v_cvt_pk_bf16_f32 v129, v101, v99
  s_waitcnt lgkmcnt(0)
  v_perm_b32 v117, v44, v40, s81
  v_perm_b32 v122, v45, v41, s81
  v_perm_b32 v125, v46, v42, s81
  v_perm_b32 v130, v47, v43, s81
  ds_write_b128 v183, v[116:119] offset:33280
  ds_write_b128 v183, v[120:123] offset:33408
  ds_write_b128 v183, v[124:127] offset:33536
  ds_write_b128 v183, v[128:131] offset:33664
  v_perm_b32 v134, v44, v40, s80
  v_perm_b32 v135, v45, v41, s80
  v_perm_b32 v136, v46, v42, s80
  v_perm_b32 v137, v47, v43, s80
  ds_write_b128 v183, v[132:135] offset:33792
  ds_write_b128 v183, v[136:139] offset:33920
  s_waitcnt lgkmcnt(0)
  s_barrier
  ds_read_b128 v[20:23], v184 offset:33280
  ds_read_b128 v[24:27], v184 offset:33408
  ds_read_b128 v[28:31], v184 offset:33536
  ds_read_b128 v[32:35], v184 offset:33664
  ds_read_b128 v[36:39], v184 offset:33792
  ds_read_b128 v[40:43], v184 offset:33920
  s_waitcnt lgkmcnt(5)
  buffer_store_dwordx4 v[20:23], v185, s[56:59], 0 offen offset:0 sc1
  s_waitcnt lgkmcnt(4)
  buffer_store_dwordx4 v[24:27], v185, s[56:59], 0 offen offset:128 sc1
  s_waitcnt lgkmcnt(3)
  buffer_store_dwordx4 v[28:31], v185, s[56:59], 0 offen offset:256 sc1
  s_waitcnt lgkmcnt(2)
  buffer_store_dwordx4 v[32:35], v185, s[56:59], 0 offen offset:384 sc1
  s_waitcnt lgkmcnt(1)
  buffer_store_dwordx4 v[36:39], v185, s[56:59], 0 offen offset:512 sc1
  s_waitcnt lgkmcnt(0)
  buffer_store_dwordx4 v[40:43], v185, s[56:59], 0 offen offset:640 sc1
  s_waitcnt vmcnt(8)
  s_barrier
  ds_read_b128 v[160:163], v182 offset:0
  ds_read_b64 v[164:165], v182 offset:16
  ds_read_b128 v[168:171], v182 offset:2048
  ds_read_b64 v[172:173], v182 offset:2064
  ds_read_b128 v[176:179], v182 offset:4096
  ds_read_b64 v[166:167], v182 offset:4112
  s_lshr_b32 s86, s73, 1
  s_mul_i32 s85, s86, 16640
  v_and_b32 v13, 127, v0
  v_lshlrev_b32 v14, 4, v13
  v_add_u32 v186, s85, v14
  s_lshl_b32 s87, s78, 16
  s_and_b32 s88, s78, s79
  s_cmp_eq_u32 s86, 0
  s_cselect_b32 s87, s87, s88
  s_waitcnt lgkmcnt(0)
  v_lshlrev_b32 v11, 16, v164
  v_add_f32 v11, s87, v11
  v_and_b32 v12, s79, v164
  v_cvt_pk_bf16_f32 v11, v11, v12
  v_cmp_eq_u32 vcc, 1, v13
  s_nop 1
  v_cndmask_b32 v164, v164, v11, vcc
  v_alignbit_b32 v52, v161, v160, 16
  v_alignbit_b32 v53, v162, v161, 16
  v_alignbit_b32 v54, v163, v162, 16
  v_alignbit_b32 v55, v164, v163, 16
  v_mov_b32 v56, v161
  v_mov_b32 v57, v162
  v_mov_b32 v58, v163
  v_mov_b32 v59, v164
  v_alignbit_b32 v60, v162, v161, 16
  v_alignbit_b32 v61, v163, v162, 16
  v_alignbit_b32 v62, v164, v163, 16
  v_alignbit_b32 v63, v165, v164, 16
  v_mov_b32 v64, v162
  v_mov_b32 v65, v163
  v_mov_b32 v66, v164
  v_mov_b32 v67, v165
  ds_write_b128 v186, v[52:55] offset:0
  ds_write_b128 v186, v[56:59] offset:4160
  ds_write_b128 v186, v[60:63] offset:8320
  ds_write_b128 v186, v[64:67] offset:12480
  v_alignbit_b32 v68, v169, v168, 16
  v_alignbit_b32 v69, v170, v169, 16
  v_alignbit_b32 v70, v171, v170, 16
  v_alignbit_b32 v71, v172, v171, 16
  v_mov_b32 v72, v169
  v_mov_b32 v73, v170
  v_mov_b32 v74, v171
  v_mov_b32 v75, v172
  v_alignbit_b32 v76, v170, v169, 16
  v_alignbit_b32 v77, v171, v170, 16
  v_alignbit_b32 v78, v172, v171, 16
  v_alignbit_b32 v79, v173, v172, 16
  v_mov_b32 v80, v170
  v_mov_b32 v81, v171
  v_mov_b32 v82, v172
  v_mov_b32 v83, v173
  ds_write_b128 v186, v[68:71] offset:2048
  ds_write_b128 v186, v[72:75] offset:6208
  ds_write_b128 v186, v[76:79] offset:10368
  ds_write_b128 v186, v[80:83] offset:14528
  v_alignbit_b32 v84, v177, v176, 16
  v_alignbit_b32 v85, v178, v177, 16
  v_alignbit_b32 v86, v179, v178, 16
  v_alignbit_b32 v87, v166, v179, 16
  v_mov_b32 v88, v177
  v_mov_b32 v89, v178
  v_mov_b32 v90, v179
  v_mov_b32 v91, v166
  v_alignbit_b32 v92, v178, v177, 16
  v_alignbit_b32 v93, v179, v178, 16
  v_alignbit_b32 v94, v166, v179, 16
  v_alignbit_b32 v95, v167, v166, 16
  v_mov_b32 v96, v178
  v_mov_b32 v97, v179
  v_mov_b32 v98, v166
  v_mov_b32 v99, v167
  v_cmp_gt_u32 vcc, 2, v13
  s_and_saveexec_b64 s[92:93], vcc
  ds_write_b128 v186, v[84:87] offset:4096
  ds_write_b128 v186, v[88:91] offset:8256
  ds_write_b128 v186, v[92:95] offset:12416
  ds_write_b128 v186, v[96:99] offset:16576
  s_mov_b64 exec, s[92:93]
  s_waitcnt lgkmcnt(0)
  s_barrier
  s_lshr_b32 s86, s73, 1
  s_and_b32 s87, s73, 1
  s_lshl_b32 s88, s87, 8
  v_lshrrev_b32 v12, 4, v1
  v_and_b32 v11, 3, v1
  v_mul_u32_u24 v11, 4160, v11
  v_bfe_u32 v13, v1, 2, 2
  v_lshl_add_u32 v11, v13, 3, v11
  v_lshl_add_u32 v11, v12, 4, v11
  s_mul_i32 s85, s86, 16640
  s_add_u32 s85, s85, s88
  v_add_u32 v248, s85, v11
  ds_read_b64 v[48:49], v248 offset:0
  ds_read_b64 v[50:51], v248 offset:8
  ds_read_b64 v[52:53], v248 offset:512
  ds_read_b64 v[54:55], v248 offset:520
  ds_read_b64 v[56:57], v248 offset:1024
  ds_read_b64 v[58:59], v248 offset:1032
  ds_read_b64 v[60:61], v248 offset:1536
  ds_read_b64 v[62:63], v248 offset:1544
  ds_read_b64 v[64:65], v248 offset:2048
  ds_read_b64 v[66:67], v248 offset:2056
  ds_read_b64 v[68:69], v248 offset:2560
  ds_read_b64 v[70:71], v248 offset:2568
  ds_read_b64 v[72:73], v248 offset:3072
  ds_read_b64 v[74:75], v248 offset:3080
  ds_read_b64 v[76:77], v248 offset:3584
  ds_read_b64 v[78:79], v248 offset:3592
  s_lshr_b32 s86, s73, 1
  s_and_b32 s87, s73, 1
  s_lshl_b32 s88, s87, 8
  v_lshrrev_b32 v12, 4, v1
  v_and_b32 v11, 15, v1
  v_lshlrev_b32 v13, 5, v11
  v_lshlrev_b32 v14, 4, v12
  v_sub_u32 v14, v14, v13
  s_mul_i32 s85, s86, 4608
  s_add_u32 s85, s85, s88
  s_add_u32 s85, s85, 480
  v_add_u32 v249, s85, v14
  v_lshl_add_u32 v13, v12, 3, v13
  s_lshl_b32 s85, s86, 12
  s_lshl_b32 s88, s87, 10
  s_add_u32 s85, s85, s88
  v_add_u32 v252, s85, v13
  s_lshl_b32 s88, s87, 12
  s_add_u32 s88, s88, 327680
  v_lshlrev_b32 v13, 2, v13
  v_add_u32 v253, s88, v13
  v_lshrrev_b32 v13, 2, v11
  v_mul_u32_u24 v13, 57344, v13
  v_and_b32 v11, 3, v11
  v_lshl_add_u32 v13, v11, 5, v13
  v_lshl_add_u32 v13, v12, 3, v13
  s_lshl_b32 s85, s2, 1
  s_add_u32 s85, s85, s86
  s_lshl_b32 s85, s85, 7
  s_add_u32 s85, s85, 7340032
  v_add_u32 v254, s85, v13
  v_bfe_u32 v13, v1, 4, 1
  v_mul_u32_u24 v13, 229368, v13
  v_add_u32 v254, v13, v254
  s_lshl_b32 s85, s73, 12
  v_lshlrev_b32 v11, 4, v1
  v_add_u32 v255, s85, v11
  s_lshr_b32 s86, s73, 1
  v_and_b32 v13, 127, v0
  s_mul_i32 s85, s86, 4608
  v_lshl_add_u32 v20, v13, 4, s85
  v_cmp_gt_u32 s[92:93], 30, v13
  v_mov_b32 v16, 0
  v_mov_b32 v17, 0
  v_mov_b32 v18, 0
  v_mov_b32 v19, 0
  s_mov_b64 exec, s[92:93]
  ds_write_b128 v20, v[16:19] offset:37376
  s_mov_b64 exec, -1
  v_lshlrev_b32 v11, 4, v0
  v_sub_u32 v251, 4080, v11
  s_mov_b32 s84, 200000
  buffer_load_dwordx4 v[112:115], v250, s[56:59], 0 offen offset:0 sc1
  buffer_load_dwordx4 v[116:119], v250, s[56:59], 0 offen offset:128 sc1
  buffer_load_dwordx4 v[120:123], v250, s[56:59], 0 offen offset:256 sc1
Lpg1:
  s_cbranch_execz Lpg5
  buffer_load_dwordx4 v[124:127], v250, s[56:59], 0 offen offset:384 sc1
  buffer_load_dwordx4 v[128:131], v250, s[56:59], 0 offen offset:512 sc1
  buffer_load_dwordx4 v[132:135], v250, s[56:59], 0 offen offset:640 sc1
  s_waitcnt vmcnt(0)
  v_xor_b32 v12, s72, v112
  v_bitop3_b32 v12, v12, v119, s72 bitop3:0xf6
  v_bitop3_b32 v12, v12, v120, s72 bitop3:0xf6
  v_bitop3_b32 v12, v12, v127, s72 bitop3:0xf6
  v_bitop3_b32 v12, v12, v128, s72 bitop3:0xf6
  v_bitop3_b32 v12, v12, v135, s72 bitop3:0xf6
  v_cmp_ne_u32 vcc, 0, v12
  s_cbranch_vccz Lpoll1x
Lpoll1:
  buffer_load_dwordx4 v[112:115], v250, s[56:59], 0 offen offset:0 sc1
  buffer_load_dwordx4 v[116:119], v250, s[56:59], 0 offen offset:128 sc1
  buffer_load_dwordx4 v[120:123], v250, s[56:59], 0 offen offset:256 sc1
  buffer_load_dwordx4 v[124:127], v250, s[56:59], 0 offen offset:384 sc1
  buffer_load_dwordx4 v[128:131], v250, s[56:59], 0 offen offset:512 sc1
  buffer_load_dwordx4 v[132:135], v250, s[56:59], 0 offen offset:640 sc1
  s_sub_u32 s84, s84, 1
  s_cbranch_scc1 Lpoll1y
  s_waitcnt vmcnt(0)
  v_xor_b32 v12, s72, v112
  v_bitop3_b32 v12, v12, v119, s72 bitop3:0xf6
  v_bitop3_b32 v12, v12, v120, s72 bitop3:0xf6
  v_bitop3_b32 v12, v12, v127, s72 bitop3:0xf6
  v_bitop3_b32 v12, v12, v128, s72 bitop3:0xf6
  v_bitop3_b32 v12, v12, v135, s72 bitop3:0xf6
  v_cmp_ne_u32 vcc, 0, v12
  s_cbranch_vccnz Lpoll1
Lpoll1y:
  s_waitcnt vmcnt(0)
Lpoll1x:
  ds_write_b128 v251, v[114:117] offset:33280
  ds_write_b128 v251, v[122:125] offset:37888
  ds_write_b128 v11, v[130:133] offset:42496
  v_add_u32 v11, 46592, v11
  ds_write2_b32 v11, v113, v118 offset0:0 offset1:1
  ds_write2_b32 v11, v121, v126 offset0:2 offset1:3
  s_bitcmp1_b32 s73, 0
  s_cselect_b32 s88, 1, 3
  s_lshl_b32 s87, s88, 10
  s_lshl_b32 s88, s88, 12
  buffer_load_dwordx4 v[176:179], v253, s[56:59], 0 offen offset:0
  buffer_load_dwordx4 v[180:183], v253, s[56:59], 0 offen offset:16
  buffer_load_dwordx4 v[184:187], v253, s[56:59], 0 offen offset:2048
  buffer_load_dwordx4 v[188:191], v253, s[56:59], 0 offen offset:2064
  buffer_load_dwordx4 v[192:195], v253, s[56:59], s88 offen offset:0
  buffer_load_dwordx4 v[196:199], v253, s[56:59], s88 offen offset:16
  buffer_load_dwordx4 v[200:203], v253, s[56:59], s88 offen offset:2048
  buffer_load_dwordx4 v[204:207], v253, s[56:59], s88 offen offset:2064
  s_waitcnt lgkmcnt(0)
  s_barrier
  ds_read_b128 v[112:115], v249 offset:36864
  ds_read_b128 v[116:119], v249 offset:36352
  ds_read_b128 v[120:123], v249 offset:35840
  ds_read_b128 v[124:127], v249 offset:35328
  ds_read_b128 v[128:131], v249 offset:34816
  ds_read_b128 v[132:135], v249 offset:34304
  ds_read_b128 v[136:139], v249 offset:33792
  ds_read_b128 v[140:143], v249 offset:33280
  s_waitcnt lgkmcnt(7)
  v_mfma_f32_16x16x32_bf16 v[16:19], v[48:51], v[112:115], 0
  v_mfma_f32_16x16x32_bf16 v[20:23], v[52:55], v[112:115], 0
  v_mfma_f32_16x16x32_bf16 v[24:27], v[56:59], v[112:115], 0
  v_mfma_f32_16x16x32_bf16 v[28:31], v[60:63], v[112:115], 0
  v_mfma_f32_16x16x32_bf16 v[32:35], v[64:67], v[112:115], 0
  v_mfma_f32_16x16x32_bf16 v[36:39], v[68:71], v[112:115], 0
  v_mfma_f32_16x16x32_bf16 v[40:43], v[72:75], v[112:115], 0
  v_mfma_f32_16x16x32_bf16 v[44:47], v[76:79], v[112:115], 0
  s_waitcnt lgkmcnt(6)
  v_mfma_f32_16x16x32_bf16 v[20:23], v[48:51], v[116:119], v[20:23]
  v_add_u32 v251, s87, v252
  ds_read_b64 v[208:209], v252 offset:42496
  ds_read_b64 v[210:211], v252 offset:43008
  v_mfma_f32_16x16x32_bf16 v[24:27], v[52:55], v[116:119], v[24:27]
  ds_read_b64 v[212:213], v251 offset:42496
  v_mfma_f32_16x16x32_bf16 v[28:31], v[56:59], v[116:119], v[28:31]
  ds_read_b64 v[214:215], v251 offset:43008
  v_mfma_f32_16x16x32_bf16 v[32:35], v[60:63], v[116:119], v[32:35]
  ds_read_b64 v[80:81], v248 offset:64
  ds_read_b64 v[82:83], v248 offset:72
  v_mfma_f32_16x16x32_bf16 v[36:39], v[64:67], v[116:119], v[36:39]
  ds_read_b128 v[144:147], v249 offset:36928
  v_mfma_f32_16x16x32_bf16 v[40:43], v[68:71], v[116:119], v[40:43]
  ds_read_b64 v[84:85], v248 offset:576
  v_mfma_f32_16x16x32_bf16 v[44:47], v[72:75], v[116:119], v[44:47]
  ds_read_b64 v[86:87], v248 offset:584
  s_waitcnt lgkmcnt(14)
  v_mfma_f32_16x16x32_bf16 v[24:27], v[48:51], v[120:123], v[24:27]
  ds_read_b128 v[148:151], v249 offset:36416
  ds_read_b64 v[88:89], v248 offset:1088
  v_mfma_f32_16x16x32_bf16 v[28:31], v[52:55], v[120:123], v[28:31]
  ds_read_b64 v[90:91], v248 offset:1096
  v_mfma_f32_16x16x32_bf16 v[32:35], v[56:59], v[120:123], v[32:35]
  ds_read_b128 v[152:155], v249 offset:35904
  v_mfma_f32_16x16x32_bf16 v[36:39], v[60:63], v[120:123], v[36:39]
  ds_read_b64 v[92:93], v248 offset:1600
  v_mfma_f32_16x16x32_bf16 v[40:43], v[64:67], v[120:123], v[40:43]
  ds_read_b64 v[94:95], v248 offset:1608
  ds_read_b128 v[156:159], v249 offset:35392
  v_mfma_f32_16x16x32_bf16 v[44:47], v[68:71], v[120:123], v[44:47]
  ds_read_b64 v[96:97], v248 offset:2112
  s_lshl_b32 s47, s2, 2
  s_add_u32 s47, s47, s73
  s_mul_i32 s47, s47, 1792
  v_lshlrev_b32 v14, 4, v1
  buffer_load_dwordx4 a[252:255], v14, s[52:55], s47 offen
  s_waitcnt lgkmcnt(15)
  v_mfma_f32_16x16x32_bf16 v[28:31], v[48:51], v[124:127], v[28:31]
  ds_read_b64 v[98:99], v248 offset:2120
  v_mfma_f32_16x16x32_bf16 v[32:35], v[52:55], v[124:127], v[32:35]
  ds_read_b128 v[160:163], v249 offset:34880
  ds_read_b64 v[100:101], v248 offset:2624
  v_mfma_f32_16x16x32_bf16 v[36:39], v[56:59], v[124:127], v[36:39]
  ds_read_b64 v[102:103], v248 offset:2632
  v_mfma_f32_16x16x32_bf16 v[40:43], v[60:63], v[124:127], v[40:43]
  ds_read_b128 v[164:167], v249 offset:34368
  v_mfma_f32_16x16x32_bf16 v[44:47], v[64:67], v[124:127], v[44:47]
  ds_read_b64 v[104:105], v248 offset:3136
  v_min_u32 v14, 752, v14
  buffer_load_dwordx4 a[252:255], v14, s[52:55], s47 offen offset:1024
  v_mfma_f32_16x16x32_bf16 v[32:35], v[48:51], v[128:131], v[32:35]
  ds_read_b64 v[106:107], v248 offset:3144
  ds_read_b128 v[168:171], v249 offset:33856
  v_mfma_f32_16x16x32_bf16 v[36:39], v[52:55], v[128:131], v[36:39]
  ds_read_b64 v[108:109], v248 offset:3648
  v_mfma_f32_16x16x32_bf16 v[40:43], v[56:59], v[128:131], v[40:43]
  ds_read_b64 v[110:111], v248 offset:3656
  v_mfma_f32_16x16x32_bf16 v[44:47], v[60:63], v[128:131], v[44:47]
  ds_read_b128 v[172:175], v249 offset:33344
  v_mfma_f32_16x16x32_bf16 v[36:39], v[48:51], v[132:135], v[36:39]
  v_mfma_f32_16x16x32_bf16 v[40:43], v[52:55], v[132:135], v[40:43]
  v_mfma_f32_16x16x32_bf16 v[44:47], v[56:59], v[132:135], v[44:47]
  v_mfma_f32_16x16x32_bf16 v[40:43], v[48:51], v[136:139], v[40:43]
  v_mfma_f32_16x16x32_bf16 v[44:47], v[52:55], v[136:139], v[44:47]
  v_mfma_f32_16x16x32_bf16 v[44:47], v[48:51], v[140:143], v[44:47]
  s_waitcnt lgkmcnt(0)
  v_mfma_f32_16x16x32_bf16 v[16:19], v[80:83], v[144:147], v[16:19]
  ds_read_b64 v[48:49], v248 offset:128
  v_mfma_f32_16x16x32_bf16 v[20:23], v[84:87], v[144:147], v[20:23]
  ds_read_b64 v[50:51], v248 offset:136
  v_mfma_f32_16x16x32_bf16 v[24:27], v[88:91], v[144:147], v[24:27]
  ds_read_b128 v[112:115], v249 offset:36992
  s_barrier
  v_mfma_f32_16x16x32_bf16 v[28:31], v[92:95], v[144:147], v[28:31]
  ds_read_b64 v[52:53], v248 offset:640
  v_mfma_f32_16x16x32_bf16 v[32:35], v[96:99], v[144:147], v[32:35]
  ds_read_b64 v[54:55], v248 offset:648
  v_mfma_f32_16x16x32_bf16 v[36:39], v[100:103], v[144:147], v[36:39]
  ds_read_b128 v[116:119], v249 offset:36480
  v_mfma_f32_16x16x32_bf16 v[40:43], v[104:107], v[144:147], v[40:43]
  s_or_b32 s85, s77, s73
  s_cbranch_scc1 Lmba
  s_mul_i32 s85, s76, 7168
  s_add_u32 s85, s85, 69248
  v_mov_b32 v13, s72
  buffer_store_dword v13, off, s[56:59], s85 sc1
Lmba:
  v_mfma_f32_16x16x32_bf16 v[44:47], v[108:111], v[144:147], v[44:47]
  ds_read_b64 v[56:57], v248 offset:1152
  v_mfma_f32_16x16x32_bf16 v[20:23], v[80:83], v[148:151], v[20:23]
  ds_read_b64 v[58:59], v248 offset:1160
  s_add_u32 m0, s89, 16384
  s_add_u32 s83, s0, 0
  buffer_load_dwordx4 v6, s[48:51], s83 offen offset:0 lds
  v_mfma_f32_16x16x32_bf16 v[24:27], v[84:87], v[148:151], v[24:27]
  ds_read_b128 v[120:123], v249 offset:35968
  v_mfma_f32_16x16x32_bf16 v[28:31], v[88:91], v[148:151], v[28:31]
  ds_read_b64 v[60:61], v248 offset:1664
  buffer_load_dwordx4 v7, s[48:51], s83 offen offset:1024 lds
  v_mfma_f32_16x16x32_bf16 v[32:35], v[92:95], v[148:151], v[32:35]
  ds_read_b64 v[62:63], v248 offset:1672
  v_mfma_f32_16x16x32_bf16 v[36:39], v[96:99], v[148:151], v[36:39]
  ds_read_b128 v[124:127], v249 offset:35456
  v_mfma_f32_16x16x32_bf16 v[40:43], v[100:103], v[148:151], v[40:43]
  buffer_load_dwordx4 v8, s[48:51], s83 offen offset:2048 lds
  v_mfma_f32_16x16x32_bf16 v[44:47], v[104:107], v[148:151], v[44:47]
  ds_read_b64 v[64:65], v248 offset:2176
  v_mfma_f32_16x16x32_bf16 v[24:27], v[80:83], v[152:155], v[24:27]
  ds_read_b64 v[66:67], v248 offset:2184
  buffer_load_dwordx4 v9, s[48:51], s83 offen offset:3072 lds
  v_mfma_f32_16x16x32_bf16 v[28:31], v[84:87], v[152:155], v[28:31]
  ds_read_b128 v[128:131], v249 offset:34944
  v_mfma_f32_16x16x32_bf16 v[32:35], v[88:91], v[152:155], v[32:35]
  ds_read_b64 v[68:69], v248 offset:2688
  v_mfma_f32_16x16x32_bf16 v[36:39], v[92:95], v[152:155], v[36:39]
  ds_read_b64 v[70:71], v248 offset:2696
  s_add_u32 m0, s89, 20480
  s_add_u32 s83, s0, 114688
  buffer_load_dwordx4 v6, s[48:51], s83 offen offset:0 lds
  v_mfma_f32_16x16x32_bf16 v[40:43], v[96:99], v[152:155], v[40:43]
  ds_read_b128 v[132:135], v249 offset:34432
  v_mfma_f32_16x16x32_bf16 v[44:47], v[100:103], v[152:155], v[44:47]
  buffer_load_dwordx4 v7, s[48:51], s83 offen offset:1024 lds
  v_mfma_f32_16x16x32_bf16 v[28:31], v[80:83], v[156:159], v[28:31]
  ds_read_b64 v[72:73], v248 offset:3200
  v_mfma_f32_16x16x32_bf16 v[32:35], v[84:87], v[156:159], v[32:35]
  ds_read_b64 v[74:75], v248 offset:3208
  v_mfma_f32_16x16x32_bf16 v[36:39], v[88:91], v[156:159], v[36:39]
  ds_read_b128 v[136:139], v249 offset:33920
  buffer_load_dwordx4 v8, s[48:51], s83 offen offset:2048 lds
  v_mfma_f32_16x16x32_bf16 v[40:43], v[92:95], v[156:159], v[40:43]
  ds_read_b64 v[76:77], v248 offset:3712
  v_mfma_f32_16x16x32_bf16 v[44:47], v[96:99], v[156:159], v[44:47]
  ds_read_b64 v[78:79], v248 offset:3720
  buffer_load_dwordx4 v9, s[48:51], s83 offen offset:3072 lds
  v_mfma_f32_16x16x32_bf16 v[32:35], v[80:83], v[160:163], v[32:35]
  ds_read_b128 v[140:143], v249 offset:33408
  v_mfma_f32_16x16x32_bf16 v[36:39], v[84:87], v[160:163], v[36:39]
  v_mfma_f32_16x16x32_bf16 v[40:43], v[88:91], v[160:163], v[40:43]
  v_mfma_f32_16x16x32_bf16 v[44:47], v[92:95], v[160:163], v[44:47]
  v_mfma_f32_16x16x32_bf16 v[36:39], v[80:83], v[164:167], v[36:39]
  v_mfma_f32_16x16x32_bf16 v[40:43], v[84:87], v[164:167], v[40:43]
  v_mfma_f32_16x16x32_bf16 v[44:47], v[88:91], v[164:167], v[44:47]
  v_mfma_f32_16x16x32_bf16 v[40:43], v[80:83], v[168:171], v[40:43]
  v_mfma_f32_16x16x32_bf16 v[44:47], v[84:87], v[168:171], v[44:47]
  v_mfma_f32_16x16x32_bf16 v[44:47], v[80:83], v[172:175], v[44:47]
  s_waitcnt lgkmcnt(0)
  v_mfma_f32_16x16x32_bf16 v[16:19], v[48:51], v[112:115], v[16:19]
  ds_read_b64 v[80:81], v248 offset:192
  s_waitcnt vmcnt(10)
  v_xor_b32 v12, s72, v179
  v_mfma_f32_16x16x32_bf16 v[20:23], v[52:55], v[112:115], v[20:23]
  ds_read_b64 v[82:83], v248 offset:200
  v_bitop3_b32 v12, v12, v183, s72 bitop3:0xf6
  v_mfma_f32_16x16x32_bf16 v[24:27], v[56:59], v[112:115], v[24:27]
  ds_read_b128 v[144:147], v249 offset:37056
  v_bitop3_b32 v12, v12, v187, s72 bitop3:0xf6
  v_bitop3_b32 v12, v12, v191, s72 bitop3:0xf6
  v_mfma_f32_16x16x32_bf16 v[28:31], v[60:63], v[112:115], v[28:31]
  ds_read_b64 v[84:85], v248 offset:704
  v_bitop3_b32 v12, v12, v195, s72 bitop3:0xf6
  v_mfma_f32_16x16x32_bf16 v[32:35], v[64:67], v[112:115], v[32:35]
  ds_read_b64 v[86:87], v248 offset:712
  v_bitop3_b32 v12, v12, v199, s72 bitop3:0xf6
  v_bitop3_b32 v12, v12, v203, s72 bitop3:0xf6
  v_mfma_f32_16x16x32_bf16 v[36:39], v[68:71], v[112:115], v[36:39]
  ds_read_b128 v[148:151], v249 offset:36544
  v_bitop3_b32 v12, v12, v207, s72 bitop3:0xf6
  v_cmp_ne_u32 vcc, 0, v12
  v_mfma_f32_16x16x32_bf16 v[40:43], v[72:75], v[112:115], v[40:43]
  s_cbranch_vccnz Lstretry
Lstok:
  v_lshlrev_b32 v232, 16, v208
  v_mfma_f32_16x16x32_bf16 v[44:47], v[76:79], v[112:115], v[44:47]
  ds_read_b64 v[88:89], v248 offset:1216
  v_lshlrev_b32 v216, 16, v178
  v_fmac_f32 v216, v232, v176
  v_mfma_f32_16x16x32_bf16 v[20:23], v[48:51], v[116:119], v[20:23]
  ds_read_b64 v[90:91], v248 offset:1224
  v_and_b32 v233, s79, v208
  v_mfma_f32_16x16x32_bf16 v[24:27], v[52:55], v[116:119], v[24:27]
  ds_read_b128 v[152:155], v249 offset:36032
  v_and_b32 v217, s79, v178
  v_fmac_f32 v217, v233, v177
  v_mfma_f32_16x16x32_bf16 v[28:31], v[56:59], v[116:119], v[28:31]
  ds_read_b64 v[92:93], v248 offset:1728
  v_lshlrev_b32 v234, 16, v209
  v_lshlrev_b32 v218, 16, v182
  v_mfma_f32_16x16x32_bf16 v[32:35], v[60:63], v[116:119], v[32:35]
  ds_read_b64 v[94:95], v248 offset:1736
  v_fmac_f32 v218, v234, v180
  v_mfma_f32_16x16x32_bf16 v[36:39], v[64:67], v[116:119], v[36:39]
  ds_read_b128 v[156:159], v249 offset:35520
  v_and_b32 v235, s79, v209
  v_and_b32 v219, s79, v182
  v_mfma_f32_16x16x32_bf16 v[40:43], v[68:71], v[116:119], v[40:43]
  v_fmac_f32 v219, v235, v181
  v_lshlrev_b32 v236, 16, v210
  v_mfma_f32_16x16x32_bf16 v[44:47], v[72:75], v[116:119], v[44:47]
  ds_read_b64 v[96:97], v248 offset:2240
  v_lshlrev_b32 v220, 16, v186
  v_fmac_f32 v220, v236, v184
  v_mfma_f32_16x16x32_bf16 v[24:27], v[48:51], v[120:123], v[24:27]
  ds_read_b64 v[98:99], v248 offset:2248
  v_and_b32 v237, s79, v210
  v_and_b32 v221, s79, v186
  v_mfma_f32_16x16x32_bf16 v[28:31], v[52:55], v[120:123], v[28:31]
  ds_read_b128 v[160:163], v249 offset:35008
  v_fmac_f32 v221, v237, v185
  v_mfma_f32_16x16x32_bf16 v[32:35], v[56:59], v[120:123], v[32:35]
  ds_read_b64 v[100:101], v248 offset:2752
  v_lshlrev_b32 v238, 16, v211
  v_lshlrev_b32 v222, 16, v190
  v_mfma_f32_16x16x32_bf16 v[36:39], v[60:63], v[120:123], v[36:39]
  ds_read_b64 v[102:103], v248 offset:2760
  v_fmac_f32 v222, v238, v188
  v_mfma_f32_16x16x32_bf16 v[40:43], v[64:67], v[120:123], v[40:43]
  ds_read_b128 v[164:167], v249 offset:34496
  v_and_b32 v239, s79, v211
  v_and_b32 v223, s79, v190
  v_mfma_f32_16x16x32_bf16 v[44:47], v[68:71], v[120:123], v[44:47]
  v_fmac_f32 v223, v239, v189
  v_lshlrev_b32 v240, 16, v212
  v_mfma_f32_16x16x32_bf16 v[28:31], v[48:51], v[124:127], v[28:31]
  ds_read_b64 v[104:105], v248 offset:3264
  v_lshlrev_b32 v224, 16, v194
  v_fmac_f32 v224, v240, v192
  v_mfma_f32_16x16x32_bf16 v[32:35], v[52:55], v[124:127], v[32:35]
  ds_read_b64 v[106:107], v248 offset:3272
  v_and_b32 v241, s79, v212
  v_and_b32 v225, s79, v194
  v_mfma_f32_16x16x32_bf16 v[36:39], v[56:59], v[124:127], v[36:39]
  ds_read_b128 v[168:171], v249 offset:33984
  v_fmac_f32 v225, v241, v193
  v_mfma_f32_16x16x32_bf16 v[40:43], v[60:63], v[124:127], v[40:43]
  ds_read_b64 v[108:109], v248 offset:3776
  v_lshlrev_b32 v242, 16, v213
  v_lshlrev_b32 v226, 16, v198
  v_mfma_f32_16x16x32_bf16 v[44:47], v[64:67], v[124:127], v[44:47]
  ds_read_b64 v[110:111], v248 offset:3784
  v_fmac_f32 v226, v242, v196
  v_mfma_f32_16x16x32_bf16 v[32:35], v[48:51], v[128:131], v[32:35]
  ds_read_b128 v[172:175], v249 offset:33472
  v_and_b32 v243, s79, v213
  v_and_b32 v227, s79, v198
  v_mfma_f32_16x16x32_bf16 v[36:39], v[52:55], v[128:131], v[36:39]
  v_fmac_f32 v227, v243, v197
  v_lshlrev_b32 v244, 16, v214
  v_lshlrev_b32 v228, 16, v202
  v_mfma_f32_16x16x32_bf16 v[40:43], v[56:59], v[128:131], v[40:43]
  v_fmac_f32 v228, v244, v200
  v_and_b32 v245, s79, v214
  v_mfma_f32_16x16x32_bf16 v[44:47], v[60:63], v[128:131], v[44:47]
  v_and_b32 v229, s79, v202
  v_fmac_f32 v229, v245, v201
  v_lshlrev_b32 v246, 16, v215
  v_mfma_f32_16x16x32_bf16 v[36:39], v[48:51], v[132:135], v[36:39]
  v_lshlrev_b32 v230, 16, v206
  v_fmac_f32 v230, v246, v204
  v_mfma_f32_16x16x32_bf16 v[40:43], v[52:55], v[132:135], v[40:43]
  v_and_b32 v247, s79, v215
  v_and_b32 v231, s79, v206
  v_fmac_f32 v231, v247, v205
  v_mfma_f32_16x16x32_bf16 v[44:47], v[56:59], v[132:135], v[44:47]
  v_mfma_f32_16x16x32_bf16 v[40:43], v[48:51], v[136:139], v[40:43]
  v_mfma_f32_16x16x32_bf16 v[44:47], v[52:55], v[136:139], v[44:47]
  v_mfma_f32_16x16x32_bf16 v[44:47], v[48:51], v[140:143], v[44:47]
  v_xor_b32 v251, 4096, v255
  s_bitcmp1_b32 s73, 0
  s_cbranch_scc1 Lep1
  s_waitcnt lgkmcnt(0)
  v_mfma_f32_16x16x32_bf16 v[24:27], v[88:91], v[144:147], v[24:27]
  s_cmp_eq_u32 s3, 24
  s_cselect_b32 s0, s1, s0
  s_add_u32 m0, s89, 0
  s_add_u32 s83, s0, 229376
  buffer_load_dwordx4 v6, s[48:51], s83 offen offset:0 lds
  v_mfma_f32_16x16x32_bf16 v[28:31], v[92:95], v[144:147], v[28:31]
  v_mfma_f32_16x16x32_bf16 v[32:35], v[96:99], v[144:147], v[32:35]
  v_mfma_f32_16x16x32_bf16 v[36:39], v[100:103], v[144:147], v[36:39]
  buffer_load_dwordx4 v7, s[48:51], s83 offen offset:1024 lds
  v_mfma_f32_16x16x32_bf16 v[24:27], v[84:87], v[148:151], v[24:27]
  v_mfma_f32_16x16x32_bf16 v[28:31], v[88:91], v[148:151], v[28:31]
  v_mfma_f32_16x16x32_bf16 v[32:35], v[92:95], v[148:151], v[32:35]
  v_mfma_f32_16x16x32_bf16 v[36:39], v[96:99], v[148:151], v[36:39]
  buffer_load_dwordx4 v8, s[48:51], s83 offen offset:2048 lds
  v_mfma_f32_16x16x32_bf16 v[24:27], v[80:83], v[152:155], v[24:27]
  v_mfma_f32_16x16x32_bf16 v[28:31], v[84:87], v[152:155], v[28:31]
  v_mfma_f32_16x16x32_bf16 v[32:35], v[88:91], v[152:155], v[32:35]
  buffer_load_dwordx4 v9, s[48:51], s83 offen offset:3072 lds
  v_mfma_f32_16x16x32_bf16 v[36:39], v[92:95], v[152:155], v[36:39]
  ds_write_b128 v255, v[24:27] offset:42496
  v_mfma_f32_16x16x32_bf16 v[28:31], v[80:83], v[156:159], v[28:31]
  v_mfma_f32_16x16x32_bf16 v[32:35], v[84:87], v[156:159], v[32:35]
  v_mfma_f32_16x16x32_bf16 v[36:39], v[88:91], v[156:159], v[36:39]
  s_add_u32 m0, s89, 4096
  s_add_u32 s83, s0, 344064
  buffer_load_dwordx4 v6, s[48:51], s83 offen offset:0 lds
  v_mfma_f32_16x16x32_bf16 v[32:35], v[80:83], v[160:163], v[32:35]
  ds_write_b128 v255, v[28:31] offset:43520
  v_mfma_f32_16x16x32_bf16 v[36:39], v[84:87], v[160:163], v[36:39]
  v_mfma_f32_16x16x32_bf16 v[36:39], v[80:83], v[164:167], v[36:39]
  buffer_load_dwordx4 v7, s[48:51], s83 offen offset:1024 lds
  v_mfma_f32_16x16x32_bf16 v[16:19], v[80:83], v[144:147], v[16:19]
  ds_write_b128 v255, v[32:35] offset:44544
  v_mfma_f32_16x16x32_bf16 v[20:23], v[84:87], v[144:147], v[20:23]
  v_mfma_f32_16x16x32_bf16 v[40:43], v[104:107], v[144:147], v[40:43]
  ds_write_b128 v255, v[36:39] offset:45568
  v_mfma_f32_16x16x32_bf16 v[44:47], v[108:111], v[144:147], v[44:47]
  buffer_load_dwordx4 v8, s[48:51], s83 offen offset:2048 lds
  v_mfma_f32_16x16x32_bf16 v[20:23], v[80:83], v[148:151], v[20:23]
  s_waitcnt lgkmcnt(0)
  s_barrier
  v_mfma_f32_16x16x32_bf16 v[40:43], v[100:103], v[148:151], v[40:43]
  ds_read_b128 v[48:51], v251 offset:42496
  ds_read_b128 v[52:55], v251 offset:43520
  v_fmac_f32 v232, v216, v16
  v_fmac_f32 v233, v217, v17
  v_fmac_f32 v234, v218, v18
  v_fmac_f32 v235, v219, v19
  v_mfma_f32_16x16x32_bf16 v[44:47], v[104:107], v[148:151], v[44:47]
  buffer_load_dwordx4 v9, s[48:51], s83 offen offset:3072 lds
  ds_read_b128 v[56:59], v251 offset:44544
  ds_read_b128 v[60:63], v251 offset:45568
  v_mfma_f32_16x16x32_bf16 v[40:43], v[96:99], v[152:155], v[40:43]
  v_fmac_f32 v236, v220, v20
  v_fmac_f32 v237, v221, v21
  v_fmac_f32 v238, v222, v22
  v_fmac_f32 v239, v223, v23
  v_mfma_f32_16x16x32_bf16 v[44:47], v[100:103], v[152:155], v[44:47]
  v_mfma_f32_16x16x32_bf16 v[40:43], v[92:95], v[156:159], v[40:43]
  v_mfma_f32_16x16x32_bf16 v[44:47], v[96:99], v[156:159], v[44:47]
  s_waitcnt lgkmcnt(3)
  v_fmac_f32 v232, v216, v48
  v_fmac_f32 v233, v217, v49
  v_fmac_f32 v234, v218, v50
  v_fmac_f32 v235, v219, v51
  v_mfma_f32_16x16x32_bf16 v[40:43], v[88:91], v[160:163], v[40:43]
  s_waitcnt lgkmcnt(2)
  v_fmac_f32 v236, v220, v52
  v_fmac_f32 v237, v221, v53
  v_fmac_f32 v238, v222, v54
  v_fmac_f32 v239, v223, v55
  v_mfma_f32_16x16x32_bf16 v[44:47], v[92:95], v[160:163], v[44:47]
  v_cvt_pk_bf16_f32 v64, v232, v233
  v_cvt_pk_bf16_f32 v65, v234, v235
  v_cvt_pk_bf16_f32 v66, v236, v237
  v_cvt_pk_bf16_f32 v67, v238, v239
  v_mfma_f32_16x16x32_bf16 v[40:43], v[84:87], v[164:167], v[40:43]
  s_mov_b32 s85, 0
  v_permlane16_swap_b32 v64, v66
  v_permlane16_swap_b32 v65, v67
  buffer_store_dwordx4 v[64:67], v254, s[56:59], s85 offen sc1
  v_mfma_f32_16x16x32_bf16 v[44:47], v[88:91], v[164:167], v[44:47]
  s_waitcnt lgkmcnt(1)
  v_fmac_f32 v240, v224, v56
  v_fmac_f32 v241, v225, v57
  v_fmac_f32 v242, v226, v58
  v_fmac_f32 v243, v227, v59
  v_mfma_f32_16x16x32_bf16 v[40:43], v[80:83], v[168:171], v[40:43]
  s_waitcnt lgkmcnt(0)
  v_fmac_f32 v244, v228, v60
  v_fmac_f32 v245, v229, v61
  v_fmac_f32 v246, v230, v62
  v_fmac_f32 v247, v231, v63
  v_mfma_f32_16x16x32_bf16 v[44:47], v[84:87], v[168:171], v[44:47]
  v_mfma_f32_16x16x32_bf16 v[44:47], v[80:83], v[172:175], v[44:47]
  v_fmac_f32 v240, v224, v40
  v_fmac_f32 v241, v225, v41
  v_fmac_f32 v242, v226, v42
  v_fmac_f32 v243, v227, v43
  s_nop 3
  v_fmac_f32 v244, v228, v44
  v_fmac_f32 v245, v229, v45
  v_fmac_f32 v246, v230, v46
  v_fmac_f32 v247, v231, v47
  v_cvt_pk_bf16_f32 v68, v240, v241
  v_cvt_pk_bf16_f32 v69, v242, v243
  v_cvt_pk_bf16_f32 v70, v244, v245
  v_cvt_pk_bf16_f32 v71, v246, v247
  s_mov_b32 s85, 1376256
  v_permlane16_swap_b32 v68, v70
  v_permlane16_swap_b32 v69, v71
  buffer_store_dwordx4 v[68:71], v254, s[56:59], s85 offen sc1
  s_branch Lep2
Lep1:
  s_waitcnt lgkmcnt(0)
  v_mfma_f32_16x16x32_bf16 v[16:19], v[80:83], v[144:147], v[16:19]
  s_cmp_eq_u32 s3, 24
  s_cselect_b32 s0, s1, s0
  s_add_u32 m0, s89, 0
  s_add_u32 s83, s0, 229376
  buffer_load_dwordx4 v6, s[48:51], s83 offen offset:0 lds
  v_mfma_f32_16x16x32_bf16 v[20:23], v[84:87], v[144:147], v[20:23]
  v_mfma_f32_16x16x32_bf16 v[40:43], v[104:107], v[144:147], v[40:43]
  v_mfma_f32_16x16x32_bf16 v[44:47], v[108:111], v[144:147], v[44:47]
  buffer_load_dwordx4 v7, s[48:51], s83 offen offset:1024 lds
  ds_write_b128 v255, v[16:19] offset:42496
  v_mfma_f32_16x16x32_bf16 v[20:23], v[80:83], v[148:151], v[20:23]
  v_mfma_f32_16x16x32_bf16 v[40:43], v[100:103], v[148:151], v[40:43]
  v_mfma_f32_16x16x32_bf16 v[44:47], v[104:107], v[148:151], v[44:47]
  v_mfma_f32_16x16x32_bf16 v[40:43], v[96:99], v[152:155], v[40:43]
  buffer_load_dwordx4 v8, s[48:51], s83 offen offset:2048 lds
  ds_write_b128 v255, v[20:23] offset:43520
  v_mfma_f32_16x16x32_bf16 v[44:47], v[100:103], v[152:155], v[44:47]
  v_mfma_f32_16x16x32_bf16 v[40:43], v[92:95], v[156:159], v[40:43]
  v_mfma_f32_16x16x32_bf16 v[44:47], v[96:99], v[156:159], v[44:47]
  buffer_load_dwordx4 v9, s[48:51], s83 offen offset:3072 lds
  v_mfma_f32_16x16x32_bf16 v[40:43], v[88:91], v[160:163], v[40:43]
  v_mfma_f32_16x16x32_bf16 v[44:47], v[92:95], v[160:163], v[44:47]
  v_mfma_f32_16x16x32_bf16 v[40:43], v[84:87], v[164:167], v[40:43]
  v_mfma_f32_16x16x32_bf16 v[44:47], v[88:91], v[164:167], v[44:47]
  s_add_u32 m0, s89, 4096
  s_add_u32 s83, s0, 344064
  buffer_load_dwordx4 v6, s[48:51], s83 offen offset:0 lds
  v_mfma_f32_16x16x32_bf16 v[40:43], v[80:83], v[168:171], v[40:43]
  v_mfma_f32_16x16x32_bf16 v[44:47], v[84:87], v[168:171], v[44:47]
  v_mfma_f32_16x16x32_bf16 v[44:47], v[80:83], v[172:175], v[44:47]
  buffer_load_dwordx4 v7, s[48:51], s83 offen offset:1024 lds
  v_mfma_f32_16x16x32_bf16 v[24:27], v[88:91], v[144:147], v[24:27]
  ds_write_b128 v255, v[40:43] offset:44544
  v_mfma_f32_16x16x32_bf16 v[28:31], v[92:95], v[144:147], v[28:31]
  v_mfma_f32_16x16x32_bf16 v[32:35], v[96:99], v[144:147], v[32:35]
  ds_write_b128 v255, v[44:47] offset:45568
  v_mfma_f32_16x16x32_bf16 v[36:39], v[100:103], v[144:147], v[36:39]
  buffer_load_dwordx4 v8, s[48:51], s83 offen offset:2048 lds
  v_mfma_f32_16x16x32_bf16 v[24:27], v[84:87], v[148:151], v[24:27]
  s_waitcnt lgkmcnt(0)
  s_barrier
  v_mfma_f32_16x16x32_bf16 v[28:31], v[88:91], v[148:151], v[28:31]
  ds_read_b128 v[48:51], v251 offset:42496
  ds_read_b128 v[52:55], v251 offset:43520
  v_mfma_f32_16x16x32_bf16 v[32:35], v[92:95], v[148:151], v[32:35]
  buffer_load_dwordx4 v9, s[48:51], s83 offen offset:3072 lds
  ds_read_b128 v[56:59], v251 offset:44544
  ds_read_b128 v[60:63], v251 offset:45568
  v_mfma_f32_16x16x32_bf16 v[36:39], v[96:99], v[148:151], v[36:39]
  v_mfma_f32_16x16x32_bf16 v[24:27], v[80:83], v[152:155], v[24:27]
  v_mfma_f32_16x16x32_bf16 v[28:31], v[84:87], v[152:155], v[28:31]
  v_mfma_f32_16x16x32_bf16 v[32:35], v[88:91], v[152:155], v[32:35]
  s_waitcnt lgkmcnt(3)
  v_fmac_f32 v232, v216, v48
  v_fmac_f32 v233, v217, v49
  v_fmac_f32 v234, v218, v50
  v_fmac_f32 v235, v219, v51
  v_mfma_f32_16x16x32_bf16 v[36:39], v[92:95], v[152:155], v[36:39]
  s_waitcnt lgkmcnt(2)
  v_fmac_f32 v236, v220, v52
  v_fmac_f32 v237, v221, v53
  v_fmac_f32 v238, v222, v54
  v_fmac_f32 v239, v223, v55
  v_mfma_f32_16x16x32_bf16 v[28:31], v[80:83], v[156:159], v[28:31]
  v_fmac_f32 v232, v216, v24
  v_fmac_f32 v233, v217, v25
  v_fmac_f32 v234, v218, v26
  v_fmac_f32 v235, v219, v27
  v_mfma_f32_16x16x32_bf16 v[32:35], v[84:87], v[156:159], v[32:35]
  v_mfma_f32_16x16x32_bf16 v[36:39], v[88:91], v[156:159], v[36:39]
  v_mfma_f32_16x16x32_bf16 v[32:35], v[80:83], v[160:163], v[32:35]
  v_fmac_f32 v236, v220, v28
  v_fmac_f32 v237, v221, v29
  v_fmac_f32 v238, v222, v30
  v_fmac_f32 v239, v223, v31
  v_mfma_f32_16x16x32_bf16 v[36:39], v[84:87], v[160:163], v[36:39]
  v_cvt_pk_bf16_f32 v64, v232, v233
  v_cvt_pk_bf16_f32 v65, v234, v235
  v_cvt_pk_bf16_f32 v66, v236, v237
  v_cvt_pk_bf16_f32 v67, v238, v239
  v_mfma_f32_16x16x32_bf16 v[36:39], v[80:83], v[164:167], v[36:39]
  s_mov_b32 s85, 458752
  v_permlane16_swap_b32 v64, v66
  v_permlane16_swap_b32 v65, v67
  buffer_store_dwordx4 v[64:67], v254, s[56:59], s85 offen sc1
  s_waitcnt lgkmcnt(1)
  v_fmac_f32 v240, v224, v56
  v_fmac_f32 v241, v225, v57
  v_fmac_f32 v242, v226, v58
  v_fmac_f32 v243, v227, v59
  s_waitcnt lgkmcnt(0)
  v_fmac_f32 v244, v228, v60
  v_fmac_f32 v245, v229, v61
  v_fmac_f32 v246, v230, v62
  v_fmac_f32 v247, v231, v63
  v_fmac_f32 v240, v224, v32
  v_fmac_f32 v241, v225, v33
  v_fmac_f32 v242, v226, v34
  v_fmac_f32 v243, v227, v35
  v_fmac_f32 v244, v228, v36
  v_fmac_f32 v245, v229, v37
  v_fmac_f32 v246, v230, v38
  v_fmac_f32 v247, v231, v39
  v_cvt_pk_bf16_f32 v68, v240, v241
  v_cvt_pk_bf16_f32 v69, v242, v243
  v_cvt_pk_bf16_f32 v70, v244, v245
  v_cvt_pk_bf16_f32 v71, v246, v247
  s_mov_b32 s85, 917504
  v_permlane16_swap_b32 v68, v70
  v_permlane16_swap_b32 v69, v71
  buffer_store_dwordx4 v[68:71], v254, s[56:59], s85 offen sc1
Lep2:
  v_mov_b32 v212, v6
  v_mov_b32 v213, v7
  v_mov_b32 v214, v8
  v_mov_b32 v215, v9
  s_cmp_eq_u32 s3, 20
  s_cselect_b32 s0, s1, s0
  s_add_u32 m0, s89, 8192
  s_add_u32 s83, s0, 458752
  buffer_load_dwordx4 v212, s[48:51], s83 offen offset:0 lds
  s_waitcnt vmcnt(15)
  ds_read_b64_tr_b16 a[0:1], v2 offset:16384
  ds_read_b64_tr_b16 a[2:3], v2 offset:16896
  ds_read_b64_tr_b16 a[4:5], v3 offset:16384
  ds_read_b64_tr_b16 a[6:7], v3 offset:16896
  ds_read_b64_tr_b16 a[8:9], v2 offset:18432
  ds_read_b64_tr_b16 a[10:11], v2 offset:18944
  ds_read_b64_tr_b16 a[12:13], v3 offset:18432
  ds_read_b64_tr_b16 a[14:15], v3 offset:18944
  buffer_load_dwordx4 v213, s[48:51], s83 offen offset:1024 lds
  s_waitcnt vmcnt(12)
  ds_read_b64_tr_b16 a[16:17], v2 offset:20480
  ds_read_b64_tr_b16 a[18:19], v2 offset:20992
  ds_read_b64_tr_b16 a[20:21], v3 offset:20480
  ds_read_b64_tr_b16 a[22:23], v3 offset:20992
  ds_read_b64_tr_b16 a[24:25], v2 offset:22528
  ds_read_b64_tr_b16 a[26:27], v2 offset:23040
  ds_read_b64_tr_b16 a[28:29], v3 offset:22528
  ds_read_b64_tr_b16 a[30:31], v3 offset:23040
  s_waitcnt vmcnt(8)
  ds_read_b64_tr_b16 a[32:33], v2 offset:0
  ds_read_b64_tr_b16 a[34:35], v2 offset:512
  ds_read_b64_tr_b16 a[36:37], v3 offset:0
  ds_read_b64_tr_b16 a[38:39], v3 offset:512
  ds_read_b64_tr_b16 a[40:41], v2 offset:2048
  ds_read_b64_tr_b16 a[42:43], v2 offset:2560
  ds_read_b64_tr_b16 a[44:45], v3 offset:2048
  ds_read_b64_tr_b16 a[46:47], v3 offset:2560
  buffer_load_dwordx4 v214, s[48:51], s83 offen offset:2048 lds
  s_mul_i32 s97, s77, 229376
  s_mul_i32 s85, s73, 57344
  s_add_u32 s85, s85, s97
  s_add_u32 s86, s77, 5
  s_sub_u32 s88, s86, 7
Lpg2:
  s_cbranch_execz Lpgr_p0
  s_min_u32 s86, s86, s88
  s_lshl_b32 s86, s86, 7
  s_add_u32 s32, s85, s86
  s_add_u32 s86, s77, 6
  s_sub_u32 s88, s86, 7
  s_min_u32 s86, s86, s88
  buffer_load_dwordx4 v215, s[48:51], s83 offen offset:3072 lds
  s_lshl_b32 s86, s86, 7
  s_add_u32 s33, s85, s86
  s_lshl_b32 s86, s77, 7
  s_add_u32 s34, s85, s86
  v_lshrrev_b32 v11, 3, v1
  v_lshrrev_b32 v12, 2, v1
  v_and_b32 v12, 4, v12
  v_and_b32 v13, 7, v1
  v_xor_b32 v12, v12, v13
  v_lshlrev_b32 v12, 4, v12
  v_mul_u32_u24 v11, 896, v11
  s_add_u32 m0, s89, 12288
  s_add_u32 s83, s0, 573440
  buffer_load_dwordx4 v212, s[48:51], s83 offen offset:0 lds
  v_add_u32 v6, v11, v12
  v_add_u32 v7, 6144, v6
  v_add_u32 v8, 12288, v6
  v_add_u32 v9, 18432, v6
  v_min_u32 v228, 223, v0
  v_mul_u32_u24 v228, 12, v228
  s_and_b32 s85, s2, 7
  s_mul_i32 s85, s85, 4096
  s_add_u32 s85, s85, 4096
  buffer_load_dwordx4 v213, s[48:51], s83 offen offset:1024 lds
  v_add_u32 v228, s85, v228
  v_lshlrev_b32 v124, 16, v10
  v_lshlrev_b32 v125, 16, v15
  v_lshrrev_b32 v208, 4, v1
  v_lshrrev_b32 v209, 2, v1
  v_xor_b32 v208, v208, v209
  v_and_b32 v208, 1, v208
  v_cmp_eq_u32 vcc, 0, v208
  v_mov_b32 v208, 0x3f803f80
  s_mul_i32 s37, s76, 57344
  s_add_u32 s46, s37, 0
  buffer_load_dwordx4 v214, s[48:51], s83 offen offset:2048 lds
  s_add_u32 s37, s37, 7340032
  s_lshl_b32 s85, s77, 7
  s_add_u32 s46, s46, s85
  s_lshl_b32 s85, s73, 5
  s_add_u32 s46, s46, s85
  s_add_u32 s86, s77, s73
  s_add_u32 s86, s86, 1
  s_sub_u32 s88, s86, 7
  s_min_u32 s86, s86, s88
  s_lshl_b32 s85, s86, 7
  s_add_u32 s97, s97, s85
  buffer_load_dwordx4 v215, s[48:51], s83 offen offset:3072 lds
  s_mul_i32 s87, s76, 344064
  s_add_u32 s87, s87, 9437184
  s_mul_i32 s86, s86, 6
  s_add_u32 s86, s86, s73
  s_lshl_b32 s86, s86, 12
  s_add_u32 s35, s86, s87
  s_lshr_b32 s85, s73, 1
  s_waitcnt vmcnt(10)
  ds_read_b64_tr_b16 a[48:49], v2 offset:4096
  ds_read_b64_tr_b16 a[50:51], v2 offset:4608
  ds_read_b64_tr_b16 a[52:53], v3 offset:4096
  ds_read_b64_tr_b16 a[54:55], v3 offset:4608
  ds_read_b64_tr_b16 a[56:57], v2 offset:6144
  ds_read_b64_tr_b16 a[58:59], v2 offset:6656
  ds_read_b64_tr_b16 a[60:61], v3 offset:6144
  ds_read_b64_tr_b16 a[62:63], v3 offset:6656
  s_waitcnt lgkmcnt(15)
  s_cmp_eq_u32 s3, 16
  s_cselect_b32 s0, s1, s0
  s_add_u32 m0, s89, 16384
  s_add_u32 s83, s0, 688128
  buffer_load_dwordx4 v212, s[48:51], s83 offen offset:0 lds
  s_add_u32 s86, s77, s85
  s_add_u32 s86, s86, 5
  s_sub_u32 s88, s86, 7
  s_min_u32 s86, s86, s88
  s_mul_i32 s86, s86, 6
  s_add_u32 s86, s86, s85
  buffer_load_dwordx4 v213, s[48:51], s83 offen offset:1024 lds
  s_add_u32 s86, s86, 4
  s_lshl_b32 s86, s86, 1
  s_and_b32 s85, s73, 1
  s_add_u32 s86, s86, s85
  s_lshl_b32 s86, s86, 11
  s_add_u32 s36, s86, s87
  s_mul_i32 s86, s77, 24
  s_add_u32 s86, s86, s73
  s_lshl_b32 s86, s86, 10
  s_add_u32 s40, s86, s87
  s_waitcnt vmcnt(10)
  s_barrier
  s_mul_i32 s84, s2, 12
  s_add_u32 s84, s84, 4096
  v_mov_b32 v222, s72
  v_mul_u32_u24 v223, 4096, v0
  v_add_u32 v223, s84, v223
  v_cmp_gt_u32 s[92:93], 8, v0
  s_mov_b64 exec, s[92:93]
  buffer_store_dword v222, v223, s[56:59], 0 offen sc1
  s_mov_b64 exec, -1
  buffer_load_dwordx4 v214, s[48:51], s83 offen offset:2048 lds
  s_add_u32 s41, s40, 4096
  s_add_u32 s42, s40, 8192
  s_add_u32 s43, s40, 12288
  s_add_u32 s44, s40, 16384
  s_add_u32 s45, s40, 20480
  s_mov_b32 s38, 0x3f80
  s_mov_b32 s39, 0x3f800000
  v_lshlrev_b32 v244, 4, v1
  v_add_u32 v245, 172032, v244
  v_mov_b32 v249, s72
  s_mul_i32 s87, s76, 7168
  buffer_load_dwordx4 v215, s[48:51], s83 offen offset:3072 lds
  s_add_u32 s87, s87, 65536
  s_lshl_b32 s85, s77, 2
  s_add_u32 s85, s85, s73
  s_lshl_b32 s85, s85, 7
  s_add_u32 s85, s85, s87
  s_add_u32 s85, s87, 3584
  s_or_b32 s86, s77, s73
  s_cselect_b32 s85, 0x7fffffff, s85
  v_mov_b32 v208, s85
  v_cmp_eq_u32 vcc, 0, v1
  v_bfrev_b32 v209, -2
  s_nop 0
  v_cndmask_b32 v248, v209, v208, vcc
  s_add_u32 m0, s89, 20480
  s_add_u32 s83, s0, 802816
  buffer_load_dwordx4 v212, s[48:51], s83 offen offset:0 lds
  v_min_u32 v208, 5, v1
  s_add_u32 s85, s77, 6
  v_sub_u32 v209, s85, v208
  v_subrev_u32 v210, 7, v209
  v_min_u32 v209, v209, v210
  s_lshr_b32 s85, s73, 1
  s_sub_u32 s85, s85, 8
  v_lshl_add_u32 v210, v208, 1, s85
  buffer_load_dwordx4 v213, s[48:51], s83 offen offset:1024 lds
  v_cmp_gt_u32 vcc, 4, v208
  s_nop 1
  v_cndmask_b32 v208, v210, v208, vcc
  v_lshl_add_u32 v208, v209, 2, v208
  v_mov_b32 v246, s87
  v_and_b32 v247, 31, v1
  v_mul_u32_u24 v247, 896, v247
  v_lshrrev_b32 v208, 5, v1
  v_lshl_add_u32 v247, v208, 4, v247
  v_lshrrev_b32 v208, 2, v1
  v_and_b32 v208, 4, v208
  s_waitcnt vmcnt(11)
  ds_read_b64_tr_b16 a[64:65], v2 offset:8192
  ds_read_b64_tr_b16 a[66:67], v2 offset:8704
  ds_read_b64_tr_b16 a[68:69], v3 offset:8192
  ds_read_b64_tr_b16 a[70:71], v3 offset:8704
  ds_read_b64_tr_b16 a[72:73], v2 offset:10240
  ds_read_b64_tr_b16 a[74:75], v2 offset:10752
  ds_read_b64_tr_b16 a[76:77], v3 offset:10240
  ds_read_b64_tr_b16 a[78:79], v3 offset:10752
  buffer_load_dwordx4 v214, s[48:51], s83 offen offset:2048 lds
  v_xor_b32 v208, v208, v1
  v_lshlrev_b32 v10, 4, v208
  s_lshl_b32 s85, s73, 11
  s_mul_i32 s87, s2, 24576
  s_add_u32 s87, s87, 1048576
  s_lshl_b32 s85, s73, 12
  s_add_u32 s70, s87, s85
  s_lshl_b32 s85, s73, 11
  s_add_u32 s85, s85, 16384
  s_add_u32 s71, s87, s85
  s_add_u32 s86, s77, 6
  buffer_load_dwordx4 v215, s[48:51], s83 offen offset:3072 lds
  s_sub_u32 s88, s86, 7
  s_min_u32 s86, s86, s88
  s_lshl_b32 s86, s86, 3
  s_and_b32 s85, s76, 7
  s_add_u32 s86, s86, s85
  s_lshl_b32 s86, s86, 3
  s_sub_u32 s88, s86, 223
  s_cmp_ge_u32 s86, 224
  s_cselect_b32 s86, s88, s86
  s_lshr_b32 s85, s76, 3
  s_lshl_b32 s85, s85, 1
  s_waitcnt lgkmcnt(15)
  s_cmp_eq_u32 s3, 12
  s_cselect_b32 s0, s1, s0
  s_add_u32 m0, s89, 0
  s_add_u32 s83, s0, 917504
  buffer_load_dwordx4 v212, s[48:51], s83 offen offset:0 lds
  s_add_u32 s86, s86, s85
  s_mul_i32 s86, s86, 24576
  s_lshl_b32 s85, s73, 10
  s_add_u32 s86, s86, s85
  s_add_u32 s64, s86, 1048576
  s_add_u32 s86, s77, 5
  buffer_load_dwordx4 v213, s[48:51], s83 offen offset:1024 lds
  s_sub_u32 s88, s86, 7
  s_min_u32 s86, s86, s88
  s_waitcnt vmcnt(11)
  ds_read_b64_tr_b16 a[80:81], v2 offset:12288
  ds_read_b64_tr_b16 a[82:83], v2 offset:12800
  ds_read_b64_tr_b16 a[84:85], v3 offset:12288
  ds_read_b64_tr_b16 a[86:87], v3 offset:12800
  ds_read_b64_tr_b16 a[88:89], v2 offset:14336
  ds_read_b64_tr_b16 a[90:91], v2 offset:14848
  ds_read_b64_tr_b16 a[92:93], v3 offset:14336
  ds_read_b64_tr_b16 a[94:95], v3 offset:14848
  buffer_load_dwordx4 v214, s[48:51], s83 offen offset:2048 lds
  s_lshl_b32 s86, s86, 3
  s_and_b32 s85, s76, 7
  s_add_u32 s86, s86, s85
  s_lshl_b32 s86, s86, 3
  s_sub_u32 s88, s86, 223
  s_cmp_ge_u32 s86, 224
  s_cselect_b32 s86, s88, s86
  s_lshr_b32 s85, s76, 3
  s_lshl_b32 s85, s85, 1
  s_add_u32 s86, s86, s85
  s_mul_i32 s86, s86, 24576
  buffer_load_dwordx4 v215, s[48:51], s83 offen offset:3072 lds
  s_lshl_b32 s85, s73, 10
  s_add_u32 s86, s86, s85
  s_add_u32 s65, s86, 1052672
  s_add_u32 s86, s77, 4
  s_sub_u32 s88, s86, 7
  s_min_u32 s86, s86, s88
  s_lshl_b32 s86, s86, 3
  s_and_b32 s85, s76, 7
  s_add_u32 s86, s86, s85
  s_lshl_b32 s86, s86, 3
  s_sub_u32 s88, s86, 223
  s_waitcnt lgkmcnt(15)
  s_add_u32 m0, s89, 4096
  s_add_u32 s83, s0, 1032192
  buffer_load_dwordx4 v212, s[48:51], s83 offen offset:0 lds
  s_cmp_ge_u32 s86, 224
  s_cselect_b32 s86, s88, s86
  s_lshr_b32 s85, s76, 3
  s_lshl_b32 s85, s85, 1
  s_add_u32 s86, s86, s85
  s_mul_i32 s86, s86, 24576
  s_lshl_b32 s85, s73, 10
  s_add_u32 s86, s86, s85
  buffer_load_dwordx4 v213, s[48:51], s83 offen offset:1024 lds
  s_add_u32 s66, s86, 1056768
  s_add_u32 s86, s77, 3
  s_sub_u32 s88, s86, 7
  s_min_u32 s86, s86, s88
  s_lshl_b32 s86, s86, 3
  s_and_b32 s85, s76, 7
  s_add_u32 s86, s86, s85
  s_lshl_b32 s86, s86, 3
  s_sub_u32 s88, s86, 223
  s_cmp_ge_u32 s86, 224
  s_cselect_b32 s86, s88, s86
  buffer_load_dwordx4 v214, s[48:51], s83 offen offset:2048 lds
  s_lshr_b32 s85, s76, 3
  s_waitcnt vmcnt(11)
  ds_read_b64_tr_b16 a[96:97], v2 offset:16384
  ds_read_b64_tr_b16 a[98:99], v2 offset:16896
  ds_read_b64_tr_b16 a[100:101], v3 offset:16384
  ds_read_b64_tr_b16 a[102:103], v3 offset:16896
  ds_read_b64_tr_b16 a[104:105], v2 offset:18432
  ds_read_b64_tr_b16 a[106:107], v2 offset:18944
  ds_read_b64_tr_b16 a[108:109], v3 offset:18432
  ds_read_b64_tr_b16 a[110:111], v3 offset:18944
  s_lshl_b32 s85, s85, 1
  buffer_load_dwordx4 v215, s[48:51], s83 offen offset:3072 lds
  s_add_u32 s86, s86, s85
  s_mul_i32 s86, s86, 24576
  s_lshl_b32 s85, s73, 10
  s_add_u32 s86, s86, s85
  s_add_u32 s67, s86, 1060864
  s_add_u32 s86, s77, 2
  s_sub_u32 s88, s86, 7
  s_min_u32 s86, s86, s88
  s_lshl_b32 s86, s86, 3
  s_and_b32 s85, s76, 7
  s_add_u32 s86, s86, s85
  s_lshl_b32 s86, s86, 3
  s_sub_u32 s88, s86, 223
  s_cmp_ge_u32 s86, 224
  s_cselect_b32 s86, s88, s86
  s_lshr_b32 s85, s76, 3
  s_lshl_b32 s85, s85, 1
  s_add_u32 s86, s86, s85
  s_mul_i32 s86, s86, 24576
  s_lshl_b32 s85, s73, 10
  s_add_u32 s86, s86, s85
  s_add_u32 s68, s86, 1064960
  s_add_u32 s86, s77, 1
  s_sub_u32 s88, s86, 7
  s_min_u32 s86, s86, s88
  s_lshl_b32 s86, s86, 3
  s_and_b32 s85, s76, 7
  s_add_u32 s86, s86, s85
  s_lshl_b32 s86, s86, 3
  s_sub_u32 s88, s86, 223
  s_cmp_ge_u32 s86, 224
  s_cselect_b32 s86, s88, s86
  s_lshr_b32 s85, s76, 3
  s_lshl_b32 s85, s85, 1
  s_add_u32 s86, s86, s85
  s_mul_i32 s86, s86, 24576
  s_lshl_b32 s85, s73, 10
  s_add_u32 s86, s86, s85
  s_add_u32 s69, s86, 1069056
  s_lshl_b32 s85, s77, 2
  s_sub_u32 s85, s85, s3
  s_cselect_b32 s86, 28, 0
  s_add_u32 s85, s85, s86
  s_cmp_lt_u32 s85, 8
  s_cselect_b32 s86, 16384, 0
  s_lshl_b32 s85, s85, 11
  s_lshl_b32 s87, s73, 11
  s_add_u32 s85, s85, s87
  v_add_u32 v242, s85, v4
  v_add_u32 v243, s85, v5
  v_add_u32 v238, s86, v244
  s_lshl_b32 s85, s73, 12
  v_add_u32 v237, s85, v238
  v_lshrrev_b32 v208, 4, v1
  v_lshlrev_b32 v208, 9, v208
  s_waitcnt vmcnt(8)
  ds_read_b64_tr_b16 a[112:113], v2 offset:20480
  ds_read_b64_tr_b16 a[114:115], v2 offset:20992
  ds_read_b64_tr_b16 a[116:117], v3 offset:20480
  ds_read_b64_tr_b16 a[118:119], v3 offset:20992
  ds_read_b64_tr_b16 a[120:121], v2 offset:22528
  ds_read_b64_tr_b16 a[122:123], v2 offset:23040
  ds_read_b64_tr_b16 a[124:125], v3 offset:22528
  ds_read_b64_tr_b16 a[126:127], v3 offset:23040
  s_waitcnt lgkmcnt(0)
  s_add_u32 m0, s89, 16384
  s_add_u32 s83, s32, 0
  buffer_load_dwordx4 v6, s[52:55], s83 offen offset:0 lds
  v_and_b32 v209, 15, v1
  v_lshl_or_b32 v208, v209, 4, v208
  v_add_u32 v241, s86, v208
  v_add_u32 v239, 79872, v208
  v_add_u32 v240, 49152, v239
  v_add_u32 v234, 79872, v244
  v_add_u32 v235, 49152, v234
  s_add_u32 s85, s89, 20480
  buffer_load_dwordx4 v7, s[52:55], s83 offen offset:1024 lds
  v_add_u32 v236, s85, v244
  v_and_b32 v208, 31, v1
  v_lshlrev_b32 v208, 3, v208
  v_add_u32 v253, 158720, v208
  v_lshrrev_b32 v209, 5, v1
  v_lshl_add_u32 v208, v209, 9, v208
  v_add_u32 v251, 157696, v208
  v_and_b32 v208, 15, v1
  s_lshl_b32 s85, s73, 7
  s_add_u32 s85, s85, 157696
  v_lshl_add_u32 v250, v208, 3, s85
  buffer_load_dwordx4 v8, s[52:55], s83 offen offset:2048 lds
  v_lshlrev_b32 v209, 3, v1
  v_add_u32 v209, 57344, v209
  v_lshrrev_b32 v208, 2, v208
  v_lshrrev_b32 v210, 4, v1
  v_cmp_eq_u32 vcc, v208, v210
  s_nop 1
  v_cndmask_b32 v250, v209, v250, vcc
  v_lshl_add_u32 v210, v210, 3, v208
  v_lshlrev_b32 v210, 7, v210
  v_lshrrev_b32 v208, 1, v208
  v_lshlrev_b32 v208, 6, v208
  s_lshl_b32 s85, s73, 5
  buffer_load_dwordx4 v9, s[52:55], s83 offen offset:3072 lds
  v_xor_b32 v208, s85, v208
  v_and_b32 v209, 3, v1
  s_waitcnt vmcnt(8)
  ds_read_b64_tr_b16 a[128:129], v2 offset:0
  ds_read_b64_tr_b16 a[130:131], v2 offset:512
  ds_read_b64_tr_b16 a[132:133], v3 offset:0
  ds_read_b64_tr_b16 a[134:135], v3 offset:512
  ds_read_b64_tr_b16 a[136:137], v2 offset:2048
  ds_read_b64_tr_b16 a[138:139], v2 offset:2560
  ds_read_b64_tr_b16 a[140:141], v3 offset:2048
  ds_read_b64_tr_b16 a[142:143], v3 offset:2560
  s_add_u32 m0, s89, 20480
  s_add_u32 s83, s33, 0
  buffer_load_dwordx4 v6, s[52:55], s83 offen offset:0 lds
  v_lshl_or_b32 v208, v209, 3, v208
  v_or_b32 v232, v208, v210
  s_mov_b32 s90, 0xaaaaaaaa
  s_mov_b32 s91, 0xaaaaaaaa
  s_mov_b32 s94, 0xcccccccc
  s_mov_b32 s95, 0xcccccccc
  v_mov_b32 v120, 0x3f803f80
  v_mov_b32 v121, 0x3f803f80
  v_mov_b32 v122, 0x3f803f80
  buffer_load_dwordx4 v7, s[52:55], s83 offen offset:1024 lds
  v_mov_b32 v123, 0x3f803f80
  s_cmp_lt_u32 s73, 2
  s_cselect_b32 s85, 0, 4096
  s_add_u32 s85, s85, 59392
  s_sub_u32 s85, s85, s89
  s_and_b32 s86, s73, 1
  s_lshl_b32 s86, s86, 6
  v_xor_b32 v224, s86, v2
  v_add_u32 v224, s85, v224
  v_add_u32 v225, 49152, v224
  v_lshrrev_b32 v208, 5, v1
  buffer_load_dwordx4 v8, s[52:55], s83 offen offset:2048 lds
  v_lshlrev_b32 v226, 11, v208
  v_bfe_u32 v208, v1, 4, 1
  v_lshl_or_b32 v226, v208, 10, v226
  v_bfe_u32 v208, v1, 2, 2
  v_lshl_or_b32 v226, v208, 7, v226
  v_and_b32 v208, 3, v1
  v_lshlrev_b32 v208, 3, v208
  s_lshl_b32 s85, s73, 5
  v_add_u32 v208, s85, v208
  v_bfe_u32 v209, v1, 3, 1
  v_lshlrev_b32 v209, 6, v209
  buffer_load_dwordx4 v9, s[52:55], s83 offen offset:3072 lds
  v_xor_b32 v208, v208, v209
  v_add_u32 v226, v226, v208
  s_waitcnt vmcnt(8)
  ds_read_b64_tr_b16 a[144:145], v2 offset:4096
  ds_read_b64_tr_b16 a[146:147], v2 offset:4608
  ds_read_b64_tr_b16 a[148:149], v3 offset:4096
  ds_read_b64_tr_b16 a[150:151], v3 offset:4608
  ds_read_b64_tr_b16 a[152:153], v2 offset:6144
  ds_read_b64_tr_b16 a[154:155], v2 offset:6656
  ds_read_b64_tr_b16 a[156:157], v3 offset:6144
  ds_read_b64_tr_b16 a[158:159], v3 offset:6656
  buffer_load_dword v229, v228, s[56:59], 0 offen sc1
  v_add_u32 v226, 71680, v226
  v_add_u32 v227, 49152, v226
  s_lshl_b32 s84, s96, 2
  s_add_u32 s84, s84, 360448
  v_and_b32 v52, 31, v1
  v_lshl_add_u32 v52, v52, 4, s84
  s_waitcnt lgkmcnt(0)
  s_add_u32 m0, s89, 0
  s_add_u32 s83, s32, 28672
  buffer_load_dwordx4 v6, s[52:55], s83 offen offset:0 lds
  buffer_load_dwordx4 v7, s[52:55], s83 offen offset:1024 lds
  buffer_load_dwordx4 v8, s[52:55], s83 offen offset:2048 lds
  buffer_load_dwordx4 v9, s[52:55], s83 offen offset:3072 lds
  s_add_u32 m0, s89, 4096
  s_add_u32 s83, s33, 28672
  buffer_load_dwordx4 v6, s[52:55], s83 offen offset:0 lds
  buffer_load_dwordx4 v7, s[52:55], s83 offen offset:1024 lds
  buffer_load_dwordx4 v8, s[52:55], s83 offen offset:2048 lds
  buffer_load_dwordx4 v9, s[52:55], s83 offen offset:3072 lds
  buffer_store_dword v249, v248, s[56:59], 0 offen sc1
  s_waitcnt vmcnt(9)
  v_cmp_ne_u32 vcc, s72, v229
  s_cbranch_vccnz Lp2
Lp2x:
  s_barrier
  s_lshl_b32 s86, s3, 11
  s_lshl_b32 m0, s73, 11
  s_add_u32 s83, s86, m0
  s_sub_u32 s87, s83, 57344
  s_cselect_b32 s83, s83, s87
  s_add_u32 s83, s83, s37
  buffer_load_dwordx4 v10, s[56:59], s83 offen offset:0 lds
  buffer_load_dwordx4 v10, s[56:59], s83 offen offset:1024 lds
  s_lshl_b32 s85, s73, 12
  s_add_u32 m0, s85, 8192
  s_add_u32 s83, s86, m0
  s_sub_u32 s87, s83, 57344
  s_cselect_b32 s83, s83, s87
  s_add_u32 s83, s83, s37
  buffer_load_dwordx4 v10, s[56:59], s83 offen offset:0 lds
  ds_read_b64_tr_b16 v[144:145], v224 offset:16384
  buffer_load_dwordx4 v10, s[56:59], s83 offen offset:1024 lds
  ds_read_b64_tr_b16 v[146:147], v224 offset:16896
  buffer_load_dwordx4 v10, s[56:59], s83 offen offset:2048 lds
  ds_read_b64_tr_b16 v[148:149], v224 offset:18432
  ds_read_b64_tr_b16 v[150:151], v224 offset:18944
  buffer_load_dwordx4 v10, s[56:59], s83 offen offset:3072 lds
  ds_read_b64_tr_b16 v[160:161], v224 offset:40960
  s_add_u32 m0, s85, 24576
  s_add_u32 s83, s86, m0
  s_sub_u32 s87, s83, 57344
  s_cselect_b32 s83, s83, s87
  s_add_u32 s83, s83, s37
  buffer_load_dwordx4 v10, s[56:59], s83 offen offset:0 lds
  ds_read_b64_tr_b16 v[162:163], v224 offset:41472
  buffer_load_dwordx4 v10, s[56:59], s83 offen offset:1024 lds
  ds_read_b64_tr_b16 v[164:165], v224 offset:43008
  ds_read_b64_tr_b16 v[166:167], v224 offset:43520
  buffer_load_dwordx4 v10, s[56:59], s83 offen offset:2048 lds
  ds_read_b64_tr_b16 v[176:177], v225 offset:16384
  buffer_load_dwordx4 v10, s[56:59], s83 offen offset:3072 lds
  ds_read_b64_tr_b16 v[178:179], v225 offset:16896
  s_add_u32 m0, s85, 40960
  s_add_u32 s83, s86, m0
  s_sub_u32 s87, s83, 57344
  s_cselect_b32 s83, s83, s87
  s_add_u32 s83, s83, s37
  buffer_load_dwordx4 v10, s[56:59], s83 offen offset:0 lds
  ds_read_b64_tr_b16 v[180:181], v225 offset:18432
  ds_read_b64_tr_b16 v[182:183], v225 offset:18944
  buffer_load_dwordx4 v10, s[56:59], s83 offen offset:1024 lds
  ds_read_b64_tr_b16 v[192:193], v225 offset:40960
  buffer_load_dwordx4 v10, s[56:59], s83 offen offset:2048 lds
  ds_read_b64_tr_b16 v[194:195], v225 offset:41472
  buffer_load_dwordx4 v10, s[56:59], s83 offen offset:3072 lds
  ds_read_b64_tr_b16 v[196:197], v225 offset:43008
  ds_read_b64_tr_b16 v[198:199], v225 offset:43520
  s_waitcnt lgkmcnt(0)
  s_waitcnt vmcnt(12)
  s_barrier
  ds_read_b64_tr_b16 v[80:81], v4 offset:0
  ds_read_b64_tr_b16 v[82:83], v4 offset:512
  ds_read_b64_tr_b16 v[84:85], v4 offset:2048
  ds_read_b64_tr_b16 v[86:87], v4 offset:2560
  ds_read_b64_tr_b16 v[96:97], v232 offset:0
  ds_read_b64_tr_b16 v[98:99], v232 offset:512
  ds_read_b64_tr_b16 v[100:101], v232 offset:4096
  ds_read_b64_tr_b16 v[102:103], v232 offset:4608
  s_waitcnt lgkmcnt(0)
  v_mfma_f32_32x32x16_bf16 v[16:31], a[0:3], v[80:83], 0
  ds_read_b64_tr_b16 v[88:89], v4 offset:4096
  ds_read_b64_tr_b16 v[90:91], v4 offset:4608
  ds_read_b64_tr_b16 v[152:153], v224 offset:0
  v_mfma_f32_32x32x16_bf16 v[32:47], a[4:7], v[80:83], 0
  ds_read_b64_tr_b16 v[92:93], v4 offset:6144
  ds_read_b64_tr_b16 v[94:95], v4 offset:6656
  ds_read_b64_tr_b16 v[154:155], v224 offset:512
  v_mfma_f32_16x16x32_bf16 v[112:115], v[120:123], v[96:99], 0
  ds_read_b64_tr_b16 v[156:157], v224 offset:2048
  v_mfma_f32_16x16x32_bf16 v[116:119], v[96:99], v[96:99], 0
  ds_read_b64_tr_b16 v[158:159], v224 offset:2560
  v_mfma_f32_16x16x32_bf16 v[112:115], v[120:123], v[100:103], v[112:115]
  ds_read_b64_tr_b16 v[168:169], v224 offset:24576
  v_mfma_f32_16x16x32_bf16 v[116:119], v[100:103], v[100:103], v[116:119]
  ds_read_b64_tr_b16 v[170:171], v224 offset:25088
  v_mfma_f32_32x32x16_bf16 v[16:31], a[8:11], v[84:87], v[16:31]
  s_cmp_eq_u32 s3, 8
  s_cselect_b32 s0, s1, s0
  s_add_u32 m0, s89, 8192
  s_add_u32 s83, s0, 1146880
  buffer_load_dwordx4 v212, s[48:51], s83 offen offset:0 lds
  v_mfma_f32_32x32x16_bf16 v[32:47], a[12:15], v[84:87], v[32:47]
  ds_read_b64_tr_b16 v[172:173], v224 offset:26624
  ds_read_b64_tr_b16 v[174:175], v224 offset:27136
  s_waitcnt vmcnt(9)
  s_barrier
  s_waitcnt lgkmcnt(7)
  v_mfma_f32_32x32x16_bf16 v[16:31], a[16:19], v[88:91], v[16:31]
  ds_read_b64_tr_b16 v[80:81], v4 offset:8192
  ds_read_b64_tr_b16 v[82:83], v4 offset:8704
  buffer_load_dwordx4 v213, s[48:51], s83 offen offset:1024 lds
  v_mfma_f32_32x32x16_bf16 v[32:47], a[20:23], v[88:91], v[32:47]
  ds_read_b64_tr_b16 v[84:85], v4 offset:10240
  ds_read_b64_tr_b16 v[86:87], v4 offset:10752
  buffer_load_dwordx4 v214, s[48:51], s83 offen offset:2048 lds
  ds_read_b64_tr_b16 v[104:105], v232 offset:8192
  v_mfma_f32_32x32x16_bf16 v[16:31], a[24:27], v[92:95], v[16:31]
  buffer_load_dwordx4 v215, s[48:51], s83 offen offset:3072 lds
  ds_read_b64_tr_b16 v[106:107], v232 offset:8704
  ds_read_b64_tr_b16 v[108:109], v232 offset:12288
  ds_read_b64_tr_b16 v[110:111], v232 offset:12800
  v_mfma_f32_32x32x16_bf16 v[32:47], a[28:31], v[92:95], v[32:47]
  s_add_u32 m0, s89, 12288
  s_add_u32 s83, s0, 1261568
  buffer_load_dwordx4 v212, s[48:51], s83 offen offset:0 lds
  s_waitcnt lgkmcnt(4)
  v_mfma_f32_32x32x16_bf16 v[16:31], a[32:35], v[80:83], v[16:31]
  ds_read_b64_tr_b16 v[88:89], v4 offset:12288
  ds_read_b64_tr_b16 v[90:91], v4 offset:12800
  ds_read_b64_tr_b16 v[184:185], v225 offset:0
  s_waitcnt lgkmcnt(3)
  v_mfma_f32_16x16x32_bf16 v[112:115], v[120:123], v[104:107], v[112:115]
  ds_read_b64_tr_b16 v[92:93], v4 offset:14336
  ds_read_b64_tr_b16 v[94:95], v4 offset:14848
  v_mfma_f32_16x16x32_bf16 v[116:119], v[104:107], v[104:107], v[116:119]
  ds_read_b64_tr_b16 v[96:97], v232 offset:16384
  v_mfma_f32_16x16x32_bf16 v[112:115], v[120:123], v[108:111], v[112:115]
  ds_read_b64_tr_b16 v[98:99], v232 offset:16896
  v_mfma_f32_16x16x32_bf16 v[116:119], v[108:111], v[108:111], v[116:119]
  ds_read_b64_tr_b16 v[100:101], v232 offset:20480
  v_mfma_f32_32x32x16_bf16 v[32:47], a[36:39], v[80:83], v[32:47]
  buffer_load_dwordx4 v213, s[48:51], s83 offen offset:1024 lds
  ds_read_b64_tr_b16 v[186:187], v225 offset:512
  v_mfma_f32_32x32x16_bf16 v[16:31], a[40:43], v[84:87], v[16:31]
  buffer_load_dwordx4 v214, s[48:51], s83 offen offset:2048 lds
  ds_read_b64_tr_b16 v[102:103], v232 offset:20992
  v_mfma_f32_32x32x16_bf16 v[32:47], a[44:47], v[84:87], v[32:47]
  buffer_load_dwordx4 v215, s[48:51], s83 offen offset:3072 lds
  s_waitcnt vmcnt(12)
  s_barrier
  s_waitcnt lgkmcnt(5)
  v_mfma_f32_32x32x16_bf16 v[16:31], a[48:51], v[88:91], v[16:31]
  ds_read_b64_tr_b16 v[80:81], v4 offset:16384
  ds_read_b64_tr_b16 v[82:83], v4 offset:16896
  s_cmp_eq_u32 s3, 4
  s_cselect_b32 s0, s1, s0
  s_add_u32 m0, s89, 16384
  s_add_u32 s83, s0, 1376256
  buffer_load_dwordx4 v212, s[48:51], s83 offen offset:0 lds
  s_waitcnt lgkmcnt(2)
  v_mfma_f32_16x16x32_bf16 v[112:115], v[120:123], v[96:99], v[112:115]
  ds_read_b64_tr_b16 v[84:85], v4 offset:18432
  ds_read_b64_tr_b16 v[86:87], v4 offset:18944
  v_mfma_f32_16x16x32_bf16 v[116:119], v[96:99], v[96:99], v[116:119]
  buffer_load_dwordx4 v[48:51], v52, s[56:59], 0 offen sc1
  v_mfma_f32_16x16x32_bf16 v[112:115], v[120:123], v[100:103], v[112:115]
  ds_read_b64_tr_b16 v[104:105], v232 offset:24576
  v_mfma_f32_16x16x32_bf16 v[116:119], v[100:103], v[100:103], v[116:119]
  ds_read_b64_tr_b16 v[106:107], v232 offset:25088
  v_mfma_f32_32x32x16_bf16 v[32:47], a[52:55], v[88:91], v[32:47]
  buffer_load_dwordx4 v213, s[48:51], s83 offen offset:1024 lds
  ds_read_b64_tr_b16 v[108:109], v232 offset:28672
  v_mfma_f32_32x32x16_bf16 v[16:31], a[56:59], v[92:95], v[16:31]
  buffer_load_dwordx4 v214, s[48:51], s83 offen offset:2048 lds
  ds_read_b64_tr_b16 v[110:111], v232 offset:29184
  v_mfma_f32_32x32x16_bf16 v[32:47], a[60:63], v[92:95], v[32:47]
  buffer_load_dwordx4 v215, s[48:51], s83 offen offset:3072 lds
  s_waitcnt lgkmcnt(4)
  v_mfma_f32_32x32x16_bf16 v[16:31], a[64:67], v[80:83], v[16:31]
  ds_read_b64_tr_b16 v[88:89], v4 offset:20480
  ds_read_b64_tr_b16 v[90:91], v4 offset:20992
  ds_read_b64_tr_b16 v[188:189], v225 offset:2048
  s_waitcnt lgkmcnt(3)
  v_mfma_f32_16x16x32_bf16 v[112:115], v[120:123], v[104:107], v[112:115]
  ds_read_b64_tr_b16 v[92:93], v4 offset:22528
  ds_read_b64_tr_b16 v[94:95], v4 offset:23040
  v_mfma_f32_16x16x32_bf16 v[116:119], v[104:107], v[104:107], v[116:119]
  ds_read_b64_tr_b16 v[96:97], v232 offset:32768
  v_mfma_f32_16x16x32_bf16 v[112:115], v[120:123], v[108:111], v[112:115]
  ds_read_b64_tr_b16 v[98:99], v232 offset:33280
  v_mfma_f32_16x16x32_bf16 v[116:119], v[108:111], v[108:111], v[116:119]
  ds_read_b64_tr_b16 v[100:101], v232 offset:36864
  v_mfma_f32_32x32x16_bf16 v[32:47], a[68:71], v[80:83], v[32:47]
  s_add_u32 m0, s89, 20480
  s_add_u32 s83, s0, 1490944
  buffer_load_dwordx4 v212, s[48:51], s83 offen offset:0 lds
  v_mfma_f32_32x32x16_bf16 v[16:31], a[72:75], v[84:87], v[16:31]
  buffer_load_dwordx4 v213, s[48:51], s83 offen offset:1024 lds
  ds_read_b64_tr_b16 v[102:103], v232 offset:37376
  v_mfma_f32_32x32x16_bf16 v[32:47], a[76:79], v[84:87], v[32:47]
  buffer_load_dwordx4 v214, s[48:51], s83 offen offset:2048 lds
  s_waitcnt lgkmcnt(4)
  v_mfma_f32_32x32x16_bf16 v[16:31], a[80:83], v[88:91], v[16:31]
  ds_read_b64_tr_b16 v[80:81], v4 offset:24576
  ds_read_b64_tr_b16 v[82:83], v4 offset:25088
  buffer_load_dwordx4 v215, s[48:51], s83 offen offset:3072 lds
  s_waitcnt lgkmcnt(2)
  v_mfma_f32_16x16x32_bf16 v[112:115], v[120:123], v[96:99], v[112:115]
  ds_read_b64_tr_b16 v[84:85], v4 offset:26624
  ds_read_b64_tr_b16 v[86:87], v4 offset:27136
  v_mfma_f32_16x16x32_bf16 v[116:119], v[96:99], v[96:99], v[116:119]
  ds_read_b64_tr_b16 v[190:191], v225 offset:2560
  v_mfma_f32_16x16x32_bf16 v[112:115], v[120:123], v[100:103], v[112:115]
  ds_read_b64_tr_b16 v[200:201], v225 offset:24576
  v_mfma_f32_16x16x32_bf16 v[116:119], v[100:103], v[100:103], v[116:119]
Lpg3:
  s_cbranch_execz Lpgr_p0
  ds_read_b64_tr_b16 v[202:203], v225 offset:25088
  v_mfma_f32_32x32x16_bf16 v[32:47], a[84:87], v[88:91], v[32:47]
  ds_read_b64_tr_b16 v[204:205], v225 offset:26624
  ds_read_b64_tr_b16 v[206:207], v225 offset:27136
  v_mfma_f32_32x32x16_bf16 v[16:31], a[88:91], v[92:95], v[16:31]
  v_mfma_f32_32x32x16_bf16 v[32:47], a[92:95], v[92:95], v[32:47]
  s_waitcnt vmcnt(17) lgkmcnt(0)
  s_barrier
  v_mfma_f32_32x32x16_bf16 v[16:31], a[96:99], v[80:83], v[16:31]
  ds_read_b64_tr_b16 v[88:89], v4 offset:28672
  ds_read_b64_tr_b16 v[90:91], v4 offset:29184
  v_mfma_f32_32x32x16_bf16 v[32:47], a[100:103], v[80:83], v[32:47]
  ds_read_b64_tr_b16 v[92:93], v4 offset:30720
  ds_read_b64_tr_b16 v[94:95], v4 offset:31232
  ds_read_b64_tr_b16 v[104:105], v232 offset:40960
  v_mfma_f32_32x32x16_bf16 v[16:31], a[104:107], v[84:87], v[16:31]
  ds_read_b64_tr_b16 v[106:107], v232 offset:41472
  ds_read_b64_tr_b16 v[108:109], v232 offset:45056
  ds_read_b64_tr_b16 v[110:111], v232 offset:45568
  v_mfma_f32_32x32x16_bf16 v[32:47], a[108:111], v[84:87], v[32:47]
  ds_read_b64_tr_b16 v[96:97], v232 offset:49152
  ds_read_b64_tr_b16 v[98:99], v232 offset:49664
  s_waitcnt lgkmcnt(6)
  v_mfma_f32_32x32x16_bf16 v[16:31], a[112:115], v[88:91], v[16:31]
  ds_read_b64_tr_b16 v[80:81], v4 offset:32768
  ds_read_b64_tr_b16 v[82:83], v4 offset:33280
  s_waitcnt lgkmcnt(4)
  v_mfma_f32_16x16x32_bf16 v[112:115], v[120:123], v[104:107], v[112:115]
  ds_read_b64_tr_b16 v[84:85], v4 offset:34816
  ds_read_b64_tr_b16 v[86:87], v4 offset:35328
  v_mfma_f32_16x16x32_bf16 v[116:119], v[104:107], v[104:107], v[116:119]
  v_mfma_f32_16x16x32_bf16 v[112:115], v[120:123], v[108:111], v[112:115]
  ds_read_b64_tr_b16 v[100:101], v232 offset:53248
  v_mfma_f32_16x16x32_bf16 v[116:119], v[108:111], v[108:111], v[116:119]
  ds_read_b64_tr_b16 v[102:103], v232 offset:53760
  v_mfma_f32_32x32x16_bf16 v[32:47], a[116:119], v[88:91], v[32:47]
  s_waitcnt vmcnt(7)
  v_cmp_ne_u32 vcc, s72, v51
  s_cbranch_vccnz Lcs
Lcsx:
  v_cmp_gt_u32 vcc, 32, v1
  s_nop 1
  v_cndmask_b32 v124, v124, v48, vcc
  v_cndmask_b32 v125, v125, v49, vcc
  v_mfma_f32_32x32x16_bf16 v[16:31], a[120:123], v[92:95], v[16:31]
  ds_read_b64_tr_b16 a[160:161], v2 offset:8192
  ds_read_b64_tr_b16 a[162:163], v2 offset:8704
  v_and_b32 v132, s79, v124
  v_sub_f32 v133, v124, v132
  v_cvt_pk_bf16_f32 v132, v132, v132
  v_mfma_f32_32x32x16_bf16 v[32:47], a[124:127], v[92:95], v[32:47]
  ds_read_b64_tr_b16 a[164:165], v3 offset:8192
  ds_read_b64_tr_b16 a[166:167], v3 offset:8704
  v_cvt_pk_bf16_f32 v133, v133, v133
  v_and_b32 v134, s79, v125
  v_sub_f32 v135, v125, v134
  s_waitcnt lgkmcnt(6)
  v_mfma_f32_32x32x16_bf16 v[16:31], a[128:131], v[80:83], v[16:31]
  ds_read_b64_tr_b16 a[168:169], v2 offset:10240
  ds_read_b64_tr_b16 a[170:171], v2 offset:10752
  ds_read_b64_tr_b16 v[88:89], v4 offset:36864
  ds_read_b64_tr_b16 v[90:91], v4 offset:37376
  s_add_u32 m0, s89, 0
  s_add_u32 s83, s97, 0
  buffer_load_dwordx4 v6, s[52:55], s83 offen offset:0 lds
  s_waitcnt lgkmcnt(8)
  v_mfma_f32_16x16x32_bf16 v[112:115], v[120:123], v[96:99], v[112:115]
  ds_read_b64_tr_b16 a[172:173], v3 offset:10240
  ds_read_b64_tr_b16 a[174:175], v3 offset:10752
  ds_read_b64_tr_b16 v[92:93], v4 offset:38912
  ds_read_b64_tr_b16 v[94:95], v4 offset:39424
  v_mfma_f32_16x16x32_bf16 v[116:119], v[96:99], v[96:99], v[116:119]
  v_cvt_pk_bf16_f32 v134, v134, v134
  v_cvt_pk_bf16_f32 v135, v135, v135
  v_mfma_f32_16x16x32_bf16 v[112:115], v[120:123], v[100:103], v[112:115]
  buffer_load_dwordx4 v7, s[52:55], s83 offen offset:1024 lds
  v_mfma_f32_16x16x32_bf16 v[116:119], v[100:103], v[100:103], v[116:119]
  v_mfma_f32_32x32x16_bf16 v[32:47], a[132:135], v[80:83], v[32:47]
  buffer_load_dwordx4 v8, s[52:55], s83 offen offset:2048 lds
  v_mfma_f32_32x32x16_bf16 v[16:31], a[136:139], v[84:87], v[16:31]
  ds_read_b64_tr_b16 a[176:177], v2 offset:12288
  ds_read_b64_tr_b16 a[178:179], v2 offset:12800
  buffer_load_dwordx4 v9, s[52:55], s83 offen offset:3072 lds
  v_cndmask_b32 v116, v116, v117, s[90:91]
  v_cndmask_b32 v118, v118, v119, s[90:91]
  v_mul_f32 v112, -0.002232142857142857, v112
  v_mfma_f32_32x32x16_bf16 v[32:47], a[140:143], v[84:87], v[32:47]
  ds_read_b64_tr_b16 a[180:181], v3 offset:12288
  ds_read_b64_tr_b16 a[182:183], v3 offset:12800
  v_cndmask_b32 v116, v116, v118, s[94:95]
  v_and_b32 v216, s79, v112
  v_mul_f32 v116, 0.002232142857142857, v116
  v_sub_f32 v217, v112, v216
  s_waitcnt lgkmcnt(4)
  v_mfma_f32_32x32x16_bf16 v[16:31], a[144:147], v[88:91], v[16:31]
  ds_read_b64_tr_b16 a[184:185], v2 offset:14336
  ds_read_b64_tr_b16 a[186:187], v2 offset:14848
  ds_read_b64_tr_b16 v[80:81], v4 offset:40960
  ds_read_b64_tr_b16 v[82:83], v4 offset:41472
  s_add_u32 m0, s89, 4096
  s_add_u32 s83, s97, 28672
  buffer_load_dwordx4 v6, s[52:55], s83 offen offset:0 lds
  v_fma_f32 v116, -v112, v112, v116
  v_mfma_f32_32x32x16_bf16 v[32:47], a[148:151], v[88:91], v[32:47]
  ds_read_b64_tr_b16 a[188:189], v3 offset:14336
  ds_read_b64_tr_b16 a[190:191], v3 offset:14848
  ds_read_b64_tr_b16 v[84:85], v4 offset:43008
  ds_read_b64_tr_b16 v[86:87], v4 offset:43520
  v_cvt_pk_bf16_f32 v216, v216, v217
  v_max_f32 v116, 0, v116
  v_add_f32 v116, 0x3727c5ac, v116
  v_mfma_f32_32x32x16_bf16 v[16:31], a[152:155], v[92:95], v[16:31]
  s_waitcnt vmcnt(9)
  ds_read_b64_tr_b16 a[192:193], v2 offset:16384
  ds_read_b64_tr_b16 a[194:195], v2 offset:16896
  buffer_load_dwordx4 v7, s[52:55], s83 offen offset:1024 lds
  v_rsq_f32 v220, v116
  v_mov_b32 v217, v216
  v_mfma_f32_32x32x16_bf16 v[32:47], a[156:159], v[92:95], v[32:47]
  ds_read_b64_tr_b16 a[196:197], v3 offset:16384
  ds_read_b64_tr_b16 a[198:199], v3 offset:16896
  v_mul_f32 v116, v116, v220
  v_mul_f32 v221, 0x3fb8aa3b, v220
  s_waitcnt lgkmcnt(4)
  v_mfma_f32_32x32x16_bf16 v[16:31], a[160:163], v[80:83], v[16:31]
  ds_read_b64_tr_b16 a[200:201], v2 offset:18432
  ds_read_b64_tr_b16 a[202:203], v2 offset:18944
  ds_read_b64_tr_b16 v[88:89], v4 offset:45056
  ds_read_b64_tr_b16 v[90:91], v4 offset:45568
  v_and_b32 v218, s79, v116
  v_sub_f32 v219, v116, v218
  v_mfma_f32_32x32x16_bf16 v[32:47], a[164:167], v[80:83], v[32:47]
  ds_read_b64_tr_b16 a[204:205], v3 offset:18432
  ds_read_b64_tr_b16 a[206:207], v3 offset:18944
  ds_read_b64_tr_b16 v[92:93], v4 offset:47104
  ds_read_b64_tr_b16 v[94:95], v4 offset:47616
  v_cvt_pk_bf16_f32 v218, v218, v219
  v_mov_b32 v219, v218
  v_mfma_f32_32x32x16_bf16 v[16:31], a[168:171], v[84:87], v[16:31]
  s_waitcnt vmcnt(6)
  ds_read_b64_tr_b16 a[208:209], v2 offset:20480
  ds_read_b64_tr_b16 a[210:211], v2 offset:20992
  ds_write2_b64 v250, v[216:217], v[218:219] offset0:0 offset1:64
  ds_write_b64 v250, v[220:221] offset:1024
  v_mfma_f32_32x32x16_bf16 v[32:47], a[172:175], v[84:87], v[32:47]
  ds_read_b64_tr_b16 a[212:213], v3 offset:20480
  ds_read_b64_tr_b16 a[214:215], v3 offset:20992
  buffer_load_dwordx4 v8, s[52:55], s83 offen offset:2048 lds
  s_waitcnt lgkmcnt(6)
  v_mfma_f32_32x32x16_bf16 v[16:31], a[176:179], v[88:91], v[16:31]
  ds_read_b64_tr_b16 a[216:217], v2 offset:22528
  ds_read_b64_tr_b16 a[218:219], v2 offset:23040
  ds_read_b64_tr_b16 v[80:81], v4 offset:49152
  ds_read_b64_tr_b16 v[82:83], v4 offset:49664
  v_mfma_f32_32x32x16_bf16 v[32:47], a[180:183], v[88:91], v[32:47]
  ds_read_b64_tr_b16 a[220:221], v3 offset:22528
  ds_read_b64_tr_b16 a[222:223], v3 offset:23040
  ds_read_b64_tr_b16 v[84:85], v4 offset:51200
  ds_read_b64_tr_b16 v[86:87], v4 offset:51712
  buffer_load_dwordx4 v9, s[52:55], s83 offen offset:3072 lds
  v_mfma_f32_32x32x16_bf16 v[16:31], a[184:187], v[92:95], v[16:31]
  s_add_u32 m0, s89, 8192
  s_add_u32 s83, s97, 57344
  buffer_load_dwordx4 v6, s[52:55], s83 offen offset:0 lds
  v_mfma_f32_32x32x16_bf16 v[32:47], a[188:191], v[92:95], v[32:47]
  buffer_load_dwordx4 v7, s[52:55], s83 offen offset:1024 lds
  s_waitcnt lgkmcnt(0)
  v_mfma_f32_32x32x16_bf16 v[16:31], a[192:195], v[80:83], v[16:31]
  ds_read_b64_tr_b16 v[88:89], v4 offset:53248
  ds_read_b64_tr_b16 v[90:91], v4 offset:53760
  buffer_load_dwordx4 v8, s[52:55], s83 offen offset:2048 lds
  v_mfma_f32_32x32x16_bf16 v[32:47], a[196:199], v[80:83], v[32:47]
  ds_read_b64_tr_b16 v[92:93], v4 offset:55296
  ds_read_b64_tr_b16 v[94:95], v4 offset:55808
  s_barrier
  v_mfma_f32_32x32x16_bf16 v[16:31], a[200:203], v[84:87], v[16:31]
  ds_read2_b64 v[136:139], v251 offset0:0 offset1:32
  ds_read2_b64 v[140:143], v253 offset0:0 offset1:32
  v_mfma_f32_32x32x16_bf16 v[32:47], a[204:207], v[84:87], v[32:47]
  buffer_load_dwordx4 v9, s[52:55], s83 offen offset:3072 lds
  s_waitcnt lgkmcnt(2)
  v_mfma_f32_32x32x16_bf16 v[16:31], a[208:211], v[88:91], v[16:31]
  ds_read_b64_tr_b16 v[80:81], v5 offset:0
  ds_read_b64_tr_b16 v[82:83], v5 offset:512
  v_mfma_f32_32x32x16_bf16 v[32:47], a[212:215], v[88:91], v[32:47]
  ds_read_b64_tr_b16 v[84:85], v5 offset:2048
  ds_read_b64_tr_b16 v[86:87], v5 offset:2560
  s_waitcnt lgkmcnt(4)
  v_mfma_f32_32x32x8_bf16 v[16:31], v[132:133], v[136:137], v[16:31]
  v_mfma_f32_32x32x8_bf16 v[32:47], v[134:135], v[136:137], v[32:47]
  v_mfma_f32_32x32x16_bf16 v[16:31], a[216:219], v[92:95], v[16:31]
  v_mfma_f32_32x32x16_bf16 v[32:47], a[220:223], v[92:95], v[32:47]
  s_waitcnt lgkmcnt(0)
  v_mfma_f32_32x32x16_bf16 v[48:63], a[0:3], v[80:83], 0
  ds_read_b64_tr_b16 v[88:89], v5 offset:4096
  ds_read_b64_tr_b16 v[90:91], v5 offset:4608
  ds_read_b64_tr_b16 v[92:93], v5 offset:6144
  ds_read_b64_tr_b16 v[94:95], v5 offset:6656
  s_add_u32 m0, s89, 12288
  s_add_u32 s83, s97, 86016
  buffer_load_dwordx4 v6, s[52:55], s83 offen offset:0 lds
  v_mfma_f32_32x32x16_bf16 v[64:79], a[4:7], v[80:83], 0
  buffer_load_dwordx4 v7, s[52:55], s83 offen offset:1024 lds
  v_mul_f32 v208, v141, v16
  v_mul_f32 v209, v141, v17
  v_mul_f32 v210, v141, v18
  v_mul_f32 v211, v141, v19
  v_mfma_f32_32x32x16_bf16 v[48:63], a[8:11], v[84:87], v[48:63]
  v_exp_f32 v208, v208
  v_exp_f32 v209, v209
  v_exp_f32 v210, v210
  v_exp_f32 v211, v211
  v_fmaak_f32 v212, -0.5, v208, 0xbf800000
  v_fmaak_f32 v213, -0.5, v209, 0xbf800000
  v_fmaak_f32 v214, -0.5, v210, 0xbf800000
  v_mfma_f32_32x32x16_bf16 v[64:79], a[12:15], v[84:87], v[64:79]
  v_fmaak_f32 v215, -0.5, v211, 0xbf800000
  v_fmaak_f32 v208, v208, v212, 0xbf800000
  v_fmaak_f32 v209, v209, v213, 0xbf800000
  v_fmaak_f32 v210, v210, v214, 0xbf800000
  v_fmaak_f32 v211, v211, v215, 0xbf800000
  v_rcp_f32 v208, v208
  v_rcp_f32 v209, v209
  v_mfma_f32_32x32x8_bf16 v[48:63], v[132:133], v[138:139], v[48:63]
  buffer_load_dwordx4 v8, s[52:55], s83 offen offset:2048 lds
  v_rcp_f32 v210, v210
  v_rcp_f32 v211, v211
  v_fmac_f32 v16, v16, v208
  v_mfma_f32_32x32x8_bf16 v[64:79], v[134:135], v[138:139], v[64:79]
  v_fmac_f32 v17, v17, v209
  v_fmac_f32 v18, v18, v210
  v_fmac_f32 v19, v19, v211
  v_cvt_pk_bf16_f32 v16, v16, v17
  v_cvt_pk_bf16_f32 v17, v18, v19
  v_mul_f32 v216, v141, v20
  v_mul_f32 v217, v141, v21
  v_mul_f32 v218, v141, v22
  s_waitcnt lgkmcnt(0)
  s_waitcnt vmcnt(11)
  v_mfma_f32_32x32x16_bf16 v[48:63], a[16:19], v[88:91], v[48:63]
  ds_read_b64_tr_b16 v[80:81], v5 offset:8192
  ds_read_b64_tr_b16 v[82:83], v5 offset:8704
  buffer_load_dwordx4 v9, s[52:55], s83 offen offset:3072 lds
  ds_read_b64_tr_b16 a[0:1], v2 offset:0
  ds_read_b64_tr_b16 a[2:3], v2 offset:512
  v_mul_f32 v219, v141, v23
  v_mfma_f32_32x32x16_bf16 v[64:79], a[20:23], v[88:91], v[64:79]
  ds_read_b64_tr_b16 v[84:85], v5 offset:10240
  ds_read_b64_tr_b16 v[86:87], v5 offset:10752
  ds_read_b64_tr_b16 a[4:5], v3 offset:0
  ds_read_b64_tr_b16 a[6:7], v3 offset:512
  v_exp_f32 v216, v216
  v_exp_f32 v217, v217
  v_mfma_f32_32x32x16_bf16 v[48:63], a[24:27], v[92:95], v[48:63]
  s_add_u32 m0, s89, 16384
  s_add_u32 s83, s97, 114688
  buffer_load_dwordx4 v6, s[52:55], s83 offen offset:0 lds
  ds_read_b64_tr_b16 a[8:9], v2 offset:2048
  ds_read_b64_tr_b16 a[10:11], v2 offset:2560
  v_exp_f32 v218, v218
  v_mfma_f32_32x32x16_bf16 v[64:79], a[28:31], v[92:95], v[64:79]
  ds_read_b64_tr_b16 a[12:13], v3 offset:2048
  ds_read_b64_tr_b16 a[14:15], v3 offset:2560
  v_exp_f32 v219, v219
  v_fmaak_f32 v220, -0.5, v216, 0xbf800000
  v_fmaak_f32 v221, -0.5, v217, 0xbf800000
  v_fmaak_f32 v222, -0.5, v218, 0xbf800000
  s_waitcnt lgkmcnt(6)
  s_waitcnt vmcnt(9)
  v_mfma_f32_32x32x16_bf16 v[48:63], a[32:35], v[80:83], v[48:63]
  ds_read_b64_tr_b16 v[88:89], v5 offset:12288
  ds_read_b64_tr_b16 v[90:91], v5 offset:12800
  buffer_load_dwordx4 v7, s[52:55], s83 offen offset:1024 lds
  ds_read_b64_tr_b16 a[16:17], v2 offset:4096
  ds_read_b64_tr_b16 a[18:19], v2 offset:4608
  v_fmaak_f32 v223, -0.5, v219, 0xbf800000
  v_mfma_f32_32x32x16_bf16 v[64:79], a[36:39], v[80:83], v[64:79]
  ds_read_b64_tr_b16 v[92:93], v5 offset:14336
  ds_read_b64_tr_b16 v[94:95], v5 offset:14848
  ds_read_b64_tr_b16 a[20:21], v3 offset:4096
  ds_read_b64_tr_b16 a[22:23], v3 offset:4608
  v_fmaak_f32 v216, v216, v220, 0xbf800000
  v_fmaak_f32 v217, v217, v221, 0xbf800000
  v_fmaak_f32 v218, v218, v222, 0xbf800000
  v_fmaak_f32 v219, v219, v223, 0xbf800000
  v_mfma_f32_32x32x16_bf16 v[48:63], a[40:43], v[84:87], v[48:63]
  buffer_load_dwordx4 v8, s[52:55], s83 offen offset:2048 lds
  ds_read_b64_tr_b16 a[24:25], v2 offset:6144
  ds_read_b64_tr_b16 a[26:27], v2 offset:6656
  v_rcp_f32 v216, v216
  v_rcp_f32 v217, v217
  v_mfma_f32_32x32x16_bf16 v[64:79], a[44:47], v[84:87], v[64:79]
  ds_read_b64_tr_b16 a[28:29], v3 offset:6144
  ds_read_b64_tr_b16 a[30:31], v3 offset:6656
  v_rcp_f32 v218, v218
  v_rcp_f32 v219, v219
  v_fmac_f32 v20, v20, v216
  v_fmac_f32 v21, v21, v217
  s_waitcnt lgkmcnt(6)
  s_waitcnt vmcnt(7)
  v_mfma_f32_32x32x16_bf16 v[48:63], a[48:51], v[88:91], v[48:63]
  ds_read_b64_tr_b16 v[80:81], v5 offset:16384
  ds_read_b64_tr_b16 v[82:83], v5 offset:16896
  buffer_load_dwordx4 v9, s[52:55], s83 offen offset:3072 lds
  ds_read_b64_tr_b16 a[32:33], v2 offset:8192
  ds_read_b64_tr_b16 a[34:35], v2 offset:8704
  v_fmac_f32 v22, v22, v218
  v_mfma_f32_32x32x16_bf16 v[64:79], a[52:55], v[88:91], v[64:79]
  ds_read_b64_tr_b16 v[84:85], v5 offset:18432
  ds_read_b64_tr_b16 v[86:87], v5 offset:18944
  ds_read_b64_tr_b16 a[36:37], v3 offset:8192
  ds_read_b64_tr_b16 a[38:39], v3 offset:8704
  v_fmac_f32 v23, v23, v219
  v_cvt_pk_bf16_f32 v18, v20, v21
  v_cvt_pk_bf16_f32 v19, v22, v23
  v_mfma_f32_32x32x16_bf16 v[48:63], a[56:59], v[92:95], v[48:63]
  s_add_u32 m0, s89, 0
  s_add_u32 s83, s97, 143360
  buffer_load_dwordx4 v6, s[52:55], s83 offen offset:0 lds
  ds_read_b64_tr_b16 a[40:41], v2 offset:10240
  ds_read_b64_tr_b16 a[42:43], v2 offset:10752
  v_mfma_f32_32x32x16_bf16 v[64:79], a[60:63], v[92:95], v[64:79]
  ds_read_b64_tr_b16 a[44:45], v3 offset:10240
  ds_read_b64_tr_b16 a[46:47], v3 offset:10752
  ds_write_b128 v236, v[16:19] offset:0
  v_mul_f32 v208, v141, v24
  v_mul_f32 v209, v141, v25
  s_waitcnt lgkmcnt(7)
  v_mfma_f32_32x32x16_bf16 v[48:63], a[64:67], v[80:83], v[48:63]
  ds_read_b64_tr_b16 v[88:89], v5 offset:20480
  ds_read_b64_tr_b16 v[90:91], v5 offset:20992
  buffer_load_dwordx4 v7, s[52:55], s83 offen offset:1024 lds
  v_mul_f32 v210, v141, v26
  v_mul_f32 v211, v141, v27
  v_exp_f32 v208, v208
  v_mfma_f32_32x32x16_bf16 v[64:79], a[68:71], v[80:83], v[64:79]
  ds_read_b64_tr_b16 v[92:93], v5 offset:22528
  ds_read_b64_tr_b16 v[94:95], v5 offset:23040
  v_exp_f32 v209, v209
  v_exp_f32 v210, v210
  v_exp_f32 v211, v211
  v_fmaak_f32 v212, -0.5, v208, 0xbf800000
  v_mfma_f32_32x32x16_bf16 v[48:63], a[72:75], v[84:87], v[48:63]
  buffer_load_dwordx4 v8, s[52:55], s83 offen offset:2048 lds
  v_fmaak_f32 v213, -0.5, v209, 0xbf800000
  v_fmaak_f32 v214, -0.5, v210, 0xbf800000
  v_fmaak_f32 v215, -0.5, v211, 0xbf800000
  v_fmaak_f32 v208, v208, v212, 0xbf800000
  v_fmaak_f32 v209, v209, v213, 0xbf800000
  v_mfma_f32_32x32x16_bf16 v[64:79], a[76:79], v[84:87], v[64:79]
  v_fmaak_f32 v210, v210, v214, 0xbf800000
  v_fmaak_f32 v211, v211, v215, 0xbf800000
  v_rcp_f32 v208, v208
  v_rcp_f32 v209, v209
  v_rcp_f32 v210, v210
  s_waitcnt lgkmcnt(0)
  v_mfma_f32_32x32x16_bf16 v[48:63], a[80:83], v[88:91], v[48:63]
  ds_read_b64_tr_b16 v[80:81], v5 offset:24576
  ds_read_b64_tr_b16 v[82:83], v5 offset:25088
  buffer_load_dwordx4 v9, s[52:55], s83 offen offset:3072 lds
  v_rcp_f32 v211, v211
  v_fmac_f32 v24, v24, v208
  v_fmac_f32 v25, v25, v209
  v_mfma_f32_32x32x16_bf16 v[64:79], a[84:87], v[88:91], v[64:79]
  ds_read_b64_tr_b16 v[84:85], v5 offset:26624
  ds_read_b64_tr_b16 v[86:87], v5 offset:27136
  v_fmac_f32 v26, v26, v210
  v_fmac_f32 v27, v27, v211
  v_cvt_pk_bf16_f32 v24, v24, v25
  v_cvt_pk_bf16_f32 v25, v26, v27
  v_mul_f32 v216, v141, v28
  v_mul_f32 v217, v141, v29
  v_mfma_f32_32x32x16_bf16 v[48:63], a[88:91], v[92:95], v[48:63]
  s_add_u32 m0, s89, 4096
  s_add_u32 s83, s97, 172032
  buffer_load_dwordx4 v6, s[52:55], s83 offen offset:0 lds
  v_mul_f32 v218, v141, v30
  v_mul_f32 v219, v141, v31
  v_exp_f32 v216, v216
  v_mfma_f32_32x32x16_bf16 v[64:79], a[92:95], v[92:95], v[64:79]
  v_exp_f32 v217, v217
  v_exp_f32 v218, v218
  v_exp_f32 v219, v219
  v_fmaak_f32 v220, -0.5, v216, 0xbf800000
  v_fmaak_f32 v221, -0.5, v217, 0xbf800000
  s_waitcnt lgkmcnt(0)
  v_mfma_f32_32x32x16_bf16 v[48:63], a[96:99], v[80:83], v[48:63]
  ds_read_b64_tr_b16 v[88:89], v5 offset:28672
  ds_read_b64_tr_b16 v[90:91], v5 offset:29184
  buffer_load_dwordx4 v7, s[52:55], s83 offen offset:1024 lds
  v_fmaak_f32 v222, -0.5, v218, 0xbf800000
  v_fmaak_f32 v223, -0.5, v219, 0xbf800000
  v_fmaak_f32 v216, v216, v220, 0xbf800000
  v_mfma_f32_32x32x16_bf16 v[64:79], a[100:103], v[80:83], v[64:79]
  ds_read_b64_tr_b16 v[92:93], v5 offset:30720
  ds_read_b64_tr_b16 v[94:95], v5 offset:31232
  v_fmaak_f32 v217, v217, v221, 0xbf800000
  v_fmaak_f32 v218, v218, v222, 0xbf800000
  v_fmaak_f32 v219, v219, v223, 0xbf800000
  v_rcp_f32 v216, v216
  v_rcp_f32 v217, v217
  v_mfma_f32_32x32x16_bf16 v[48:63], a[104:107], v[84:87], v[48:63]
  buffer_load_dwordx4 v8, s[52:55], s83 offen offset:2048 lds
  v_rcp_f32 v218, v218
  v_rcp_f32 v219, v219
  v_fmac_f32 v28, v28, v216
  v_fmac_f32 v29, v29, v217
  v_mfma_f32_32x32x16_bf16 v[64:79], a[108:111], v[84:87], v[64:79]
  v_fmac_f32 v30, v30, v218
  v_fmac_f32 v31, v31, v219
  v_cvt_pk_bf16_f32 v26, v28, v29
  v_cvt_pk_bf16_f32 v27, v30, v31
  s_waitcnt lgkmcnt(0)
  v_mfma_f32_32x32x16_bf16 v[48:63], a[112:115], v[88:91], v[48:63]
  ds_read_b64_tr_b16 v[80:81], v5 offset:32768
  ds_read_b64_tr_b16 v[82:83], v5 offset:33280
  buffer_load_dwordx4 v9, s[52:55], s83 offen offset:3072 lds
  v_mfma_f32_32x32x16_bf16 v[64:79], a[116:119], v[88:91], v[64:79]
  ds_read_b64_tr_b16 v[84:85], v5 offset:34816
  ds_read_b64_tr_b16 v[86:87], v5 offset:35328
  ds_write_b128 v236, v[24:27] offset:1024
  v_mul_f32 v208, v141, v32
  v_mul_f32 v209, v141, v33
  v_mfma_f32_32x32x16_bf16 v[48:63], a[120:123], v[92:95], v[48:63]
  s_add_u32 m0, s89, 8192
  s_add_u32 s83, s97, 200704
  buffer_load_dwordx4 v6, s[52:55], s83 offen offset:0 lds
  v_mul_f32 v210, v141, v34
  v_mul_f32 v211, v141, v35
  v_exp_f32 v208, v208
  v_mfma_f32_32x32x16_bf16 v[64:79], a[124:127], v[92:95], v[64:79]
  v_exp_f32 v209, v209
  v_exp_f32 v210, v210
  v_exp_f32 v211, v211
  s_waitcnt lgkmcnt(1)
  s_waitcnt vmcnt(13)
  v_mfma_f32_32x32x16_bf16 v[48:63], a[128:131], v[80:83], v[48:63]
  ds_read_b64_tr_b16 v[88:89], v5 offset:36864
  ds_read_b64_tr_b16 v[90:91], v5 offset:37376
  buffer_load_dwordx4 v7, s[52:55], s83 offen offset:1024 lds
  ds_read_b64_tr_b16 a[48:49], v2 offset:12288
  ds_read_b64_tr_b16 a[50:51], v2 offset:12800
  s_waitcnt lgkmcnt(4)
  s_barrier
  v_mfma_f32_32x32x16_bf16 v[64:79], a[132:135], v[80:83], v[64:79]
  ds_read_b64_tr_b16 v[92:93], v5 offset:38912
  ds_read_b64_tr_b16 v[94:95], v5 offset:39424
  ds_read_b64_tr_b16 a[52:53], v3 offset:12288
  ds_read_b64_tr_b16 a[54:55], v3 offset:12800
  v_fmaak_f32 v212, -0.5, v208, 0xbf800000
  v_fmaak_f32 v213, -0.5, v209, 0xbf800000
  v_fmaak_f32 v214, -0.5, v210, 0xbf800000
  v_fmaak_f32 v215, -0.5, v211, 0xbf800000
  v_fmaak_f32 v208, v208, v212, 0xbf800000
  v_fmaak_f32 v209, v209, v213, 0xbf800000
  v_mfma_f32_32x32x16_bf16 v[48:63], a[136:139], v[84:87], v[48:63]
  buffer_load_dwordx4 v8, s[52:55], s83 offen offset:2048 lds
  v_fmaak_f32 v210, v210, v214, 0xbf800000
  v_fmaak_f32 v211, v211, v215, 0xbf800000
  v_rcp_f32 v208, v208
  v_mfma_f32_32x32x16_bf16 v[64:79], a[140:143], v[84:87], v[64:79]
  ds_read_b64_tr_b16 a[56:57], v2 offset:14336
  ds_read_b64_tr_b16 a[58:59], v2 offset:14848
  v_rcp_f32 v209, v209
  v_rcp_f32 v210, v210
  v_rcp_f32 v211, v211
  v_fmac_f32 v32, v32, v208
  s_waitcnt lgkmcnt(4)
  v_mfma_f32_32x32x16_bf16 v[48:63], a[144:147], v[88:91], v[48:63]
  ds_read_b64_tr_b16 v[80:81], v5 offset:40960
  ds_read_b64_tr_b16 v[82:83], v5 offset:41472
  buffer_load_dwordx4 v9, s[52:55], s83 offen offset:3072 lds
  ds_read_b64_tr_b16 a[60:61], v3 offset:14336
  ds_read_b64_tr_b16 a[62:63], v3 offset:14848
  v_fmac_f32 v33, v33, v209
  v_fmac_f32 v34, v34, v210
  v_mfma_f32_32x32x16_bf16 v[64:79], a[148:151], v[88:91], v[64:79]
  ds_read_b64_tr_b16 v[84:85], v5 offset:43008
  ds_read_b64_tr_b16 v[86:87], v5 offset:43520
  v_fmac_f32 v35, v35, v211
  v_cvt_pk_bf16_f32 v32, v32, v33
  v_cvt_pk_bf16_f32 v33, v34, v35
  v_mul_f32 v216, v141, v36
  v_mul_f32 v217, v141, v37
  v_mul_f32 v218, v141, v38
  s_waitcnt vmcnt(12)
  v_mfma_f32_32x32x16_bf16 v[48:63], a[152:155], v[92:95], v[48:63]
  ds_read_b64_tr_b16 a[64:65], v2 offset:16384
  ds_read_b64_tr_b16 a[66:67], v2 offset:16896
  v_mul_f32 v219, v141, v39
  v_exp_f32 v216, v216
  v_exp_f32 v217, v217
  v_exp_f32 v218, v218
  v_mfma_f32_32x32x16_bf16 v[64:79], a[156:159], v[92:95], v[64:79]
  ds_read_b64_tr_b16 a[68:69], v3 offset:16384
  ds_read_b64_tr_b16 a[70:71], v3 offset:16896
  v_exp_f32 v219, v219
  v_fmaak_f32 v220, -0.5, v216, 0xbf800000
  v_fmaak_f32 v221, -0.5, v217, 0xbf800000
  v_fmaak_f32 v222, -0.5, v218, 0xbf800000
  v_fmaak_f32 v223, -0.5, v219, 0xbf800000
  s_waitcnt lgkmcnt(4)
  v_mfma_f32_32x32x16_bf16 v[48:63], a[160:163], v[80:83], v[48:63]
  ds_read_b64_tr_b16 v[88:89], v5 offset:45056
  ds_read_b64_tr_b16 v[90:91], v5 offset:45568
  v_fmaak_f32 v216, v216, v220, 0xbf800000
  v_fmaak_f32 v217, v217, v221, 0xbf800000
  v_fmaak_f32 v218, v218, v222, 0xbf800000
  v_fmaak_f32 v219, v219, v223, 0xbf800000
  v_rcp_f32 v216, v216
  v_rcp_f32 v217, v217
  v_mfma_f32_32x32x16_bf16 v[64:79], a[164:167], v[80:83], v[64:79]
  ds_read_b64_tr_b16 v[92:93], v5 offset:47104
  ds_read_b64_tr_b16 v[94:95], v5 offset:47616
  ds_read_b64_tr_b16 a[72:73], v2 offset:18432
  ds_read_b64_tr_b16 a[74:75], v2 offset:18944
  v_rcp_f32 v218, v218
  v_rcp_f32 v219, v219
  v_fmac_f32 v36, v36, v216
  v_mfma_f32_32x32x16_bf16 v[48:63], a[168:171], v[84:87], v[48:63]
  ds_read_b64_tr_b16 a[76:77], v3 offset:18432
  ds_read_b64_tr_b16 a[78:79], v3 offset:18944
  v_fmac_f32 v37, v37, v217
  v_fmac_f32 v38, v38, v218
  v_fmac_f32 v39, v39, v219
  v_cvt_pk_bf16_f32 v34, v36, v37
  v_cvt_pk_bf16_f32 v35, v38, v39
  v_mfma_f32_32x32x16_bf16 v[64:79], a[172:175], v[84:87], v[64:79]
  ds_write_b128 v236, v[32:35] offset:2048
  v_mul_f32 v208, v141, v40
  v_mul_f32 v209, v141, v41
  v_mul_f32 v210, v141, v42
  s_waitcnt lgkmcnt(5)
  s_waitcnt lgkmcnt(1)
  v_mfma_f32_32x32x16_bf16 v[48:63], a[176:179], v[88:91], v[48:63]
  ds_read_b64_tr_b16 v[80:81], v5 offset:49152
  ds_read_b64_tr_b16 v[82:83], v5 offset:49664
  s_add_u32 m0, s89, 12288
  s_add_u32 s83, s34, 0
  buffer_load_dwordx4 v6, s[52:55], s83 offen offset:0 lds
  ds_read_b128 a[128:131], v234 offset:0
  v_mul_f32 v211, v141, v43
  v_mfma_f32_32x32x16_bf16 v[64:79], a[180:183], v[88:91], v[64:79]
  ds_read_b64_tr_b16 v[84:85], v5 offset:51200
  ds_read_b64_tr_b16 v[86:87], v5 offset:51712
  ds_read_b128 a[132:135], v234 offset:1024
  v_exp_f32 v208, v208
  v_exp_f32 v209, v209
  v_exp_f32 v210, v210
  v_mfma_f32_32x32x16_bf16 v[48:63], a[184:187], v[92:95], v[48:63]
  buffer_load_dwordx4 v7, s[52:55], s83 offen offset:1024 lds
  ds_read_b128 a[136:139], v234 offset:24576
  v_exp_f32 v211, v211
  v_fmaak_f32 v212, -0.5, v208, 0xbf800000
  v_fmaak_f32 v213, -0.5, v209, 0xbf800000
  v_mfma_f32_32x32x16_bf16 v[64:79], a[188:191], v[92:95], v[64:79]
  ds_read_b128 a[140:143], v234 offset:25600
  v_fmaak_f32 v214, -0.5, v210, 0xbf800000
  v_fmaak_f32 v215, -0.5, v211, 0xbf800000
  v_fmaak_f32 v208, v208, v212, 0xbf800000
  v_fmaak_f32 v209, v209, v213, 0xbf800000
  v_fmaak_f32 v210, v210, v214, 0xbf800000
  v_fmaak_f32 v211, v211, v215, 0xbf800000
  v_rcp_f32 v208, v208
  s_waitcnt lgkmcnt(3)
  v_mfma_f32_32x32x16_bf16 v[48:63], a[192:195], v[80:83], v[48:63]
  ds_read_b64_tr_b16 v[88:89], v5 offset:53248
  ds_read_b64_tr_b16 v[90:91], v5 offset:53760
  buffer_load_dwordx4 v8, s[52:55], s83 offen offset:2048 lds
  ds_read_b128 a[144:147], v235 offset:0
  v_rcp_f32 v209, v209
  v_mfma_f32_32x32x16_bf16 v[64:79], a[196:199], v[80:83], v[64:79]
  ds_read_b64_tr_b16 v[92:93], v5 offset:55296
  ds_read_b64_tr_b16 v[94:95], v5 offset:55808
  ds_read_b128 a[148:151], v235 offset:1024
  v_rcp_f32 v210, v210
  v_rcp_f32 v211, v211
  v_fmac_f32 v40, v40, v208
  v_fmac_f32 v41, v41, v209
  v_mfma_f32_32x32x16_bf16 v[48:63], a[200:203], v[84:87], v[48:63]
  buffer_load_dwordx4 v9, s[52:55], s83 offen offset:3072 lds
  ds_read_b128 a[152:155], v235 offset:24576
  v_fmac_f32 v42, v42, v210
  v_fmac_f32 v43, v43, v211
  v_cvt_pk_bf16_f32 v40, v40, v41
  v_cvt_pk_bf16_f32 v41, v42, v43
  v_mul_f32 v216, v141, v44
  v_mfma_f32_32x32x16_bf16 v[64:79], a[204:207], v[84:87], v[64:79]
  ds_read_b128 a[156:159], v235 offset:25600
  v_mul_f32 v217, v141, v45
  v_mul_f32 v218, v141, v46
  v_mul_f32 v219, v141, v47
  v_exp_f32 v216, v216
  v_exp_f32 v217, v217
  s_waitcnt lgkmcnt(3)
  v_mfma_f32_32x32x16_bf16 v[48:63], a[208:211], v[88:91], v[48:63]
  s_add_u32 m0, s89, 16384
  s_add_u32 s83, s34, 28672
  buffer_load_dwordx4 v6, s[52:55], s83 offen offset:0 lds
  v_exp_f32 v218, v218
  v_mfma_f32_32x32x16_bf16 v[64:79], a[212:215], v[88:91], v[64:79]
  v_exp_f32 v219, v219
  v_fmaak_f32 v220, -0.5, v216, 0xbf800000
Lpg4:
  s_cbranch_execz Lpgr_p0
  v_fmaak_f32 v221, -0.5, v217, 0xbf800000
  v_fmaak_f32 v222, -0.5, v218, 0xbf800000
  v_fmaak_f32 v223, -0.5, v219, 0xbf800000
  v_fmaak_f32 v216, v216, v220, 0xbf800000
  v_fmaak_f32 v217, v217, v221, 0xbf800000
  v_fmaak_f32 v218, v218, v222, 0xbf800000
  v_fmaak_f32 v219, v219, v223, 0xbf800000
  v_mfma_f32_32x32x16_bf16 v[48:63], a[216:219], v[92:95], v[48:63]
  buffer_load_dwordx4 v7, s[52:55], s83 offen offset:1024 lds
  buffer_load_dword v252, v246, s[56:59], 0 offen offset:0 sc1
  v_rcp_f32 v216, v216
  v_rcp_f32 v217, v217
  v_mfma_f32_32x32x16_bf16 v[64:79], a[220:223], v[92:95], v[64:79]
  v_rcp_f32 v218, v218
  v_rcp_f32 v219, v219
  v_fmac_f32 v44, v44, v216
  v_fmac_f32 v45, v45, v217
  v_fmac_f32 v46, v46, v218
  v_fmac_f32 v47, v47, v219
  v_cvt_pk_bf16_f32 v42, v44, v45
  v_cvt_pk_bf16_f32 v43, v46, v47
  ds_write_b128 v236, v[40:43] offset:3072
  s_waitcnt lgkmcnt(1)
  v_mfma_f32_32x32x16_bf16 v[16:31], v[144:147], a[128:131], 0
  buffer_load_dwordx4 v8, s[52:55], s83 offen offset:2048 lds
  v_mul_f32 v208, v143, v48
  v_mul_f32 v209, v143, v49
  v_mul_f32 v210, v143, v50
  v_mfma_f32_32x32x16_bf16 v[16:31], v[148:151], a[132:135], v[16:31]
  v_mul_f32 v211, v143, v51
  v_exp_f32 v208, v208
  v_exp_f32 v209, v209
  v_exp_f32 v210, v210
  v_mfma_f32_32x32x16_bf16 v[16:31], v[160:163], a[136:139], v[16:31]
  buffer_load_dwordx4 v9, s[52:55], s83 offen offset:3072 lds
  v_exp_f32 v211, v211
  v_fmaak_f32 v212, -0.5, v208, 0xbf800000
  v_mfma_f32_32x32x16_bf16 v[16:31], v[164:167], a[140:143], v[16:31]
  v_fmaak_f32 v213, -0.5, v209, 0xbf800000
  v_fmaak_f32 v214, -0.5, v210, 0xbf800000
  v_fmaak_f32 v215, -0.5, v211, 0xbf800000
  v_fmaak_f32 v208, v208, v212, 0xbf800000
  v_fmaak_f32 v209, v209, v213, 0xbf800000
  s_waitcnt lgkmcnt(0)
  s_barrier
  v_mfma_f32_32x32x16_bf16 v[16:31], v[176:179], a[144:147], v[16:31]
  ds_read_b128 a[160:163], v234 offset:2048
  ds_read_b128 a[164:167], v234 offset:3072
  v_fmaak_f32 v210, v210, v214, 0xbf800000
  v_fmaak_f32 v211, v211, v215, 0xbf800000
  v_rcp_f32 v208, v208
  v_mfma_f32_32x32x16_bf16 v[16:31], v[180:183], a[148:151], v[16:31]
  ds_read_b128 a[168:171], v234 offset:26624
  v_rcp_f32 v209, v209
  v_rcp_f32 v210, v210
  v_rcp_f32 v211, v211
  v_fmac_f32 v48, v48, v208
  v_mfma_f32_32x32x16_bf16 v[16:31], v[192:195], a[152:155], v[16:31]
  ds_read_b128 a[172:175], v234 offset:27648
  v_fmac_f32 v49, v49, v209
  v_fmac_f32 v50, v50, v210
  v_fmac_f32 v51, v51, v211
  v_cvt_pk_bf16_f32 v48, v48, v49
  v_cvt_pk_bf16_f32 v49, v50, v51
  v_mul_f32 v216, v143, v52
  v_mfma_f32_32x32x16_bf16 v[16:31], v[196:199], a[156:159], v[16:31]
  ds_read_b128 a[176:179], v235 offset:2048
  ds_read_b128 a[180:183], v235 offset:3072
  v_mul_f32 v217, v143, v53
  v_mul_f32 v218, v143, v54
  v_mul_f32 v219, v143, v55
  s_waitcnt vmcnt(17)
  s_waitcnt lgkmcnt(4)
  v_mfma_f32_32x32x16_bf16 v[16:31], v[152:155], a[160:163], v[16:31]
  ds_read_b64_tr_b16 a[80:81], v2 offset:0
  ds_read_b64_tr_b16 a[82:83], v2 offset:512
  ds_read_b128 a[184:187], v235 offset:26624
  v_exp_f32 v216, v216
  v_exp_f32 v217, v217
  v_mfma_f32_32x32x16_bf16 v[16:31], v[156:159], a[164:167], v[16:31]
  ds_read_b64_tr_b16 a[84:85], v3 offset:0
  ds_read_b64_tr_b16 a[86:87], v3 offset:512
  ds_read_b128 a[188:191], v235 offset:27648
  v_exp_f32 v218, v218
  s_waitcnt lgkmcnt(8)
  v_mfma_f32_32x32x16_bf16 v[16:31], v[168:171], a[168:171], v[16:31]
  ds_read_b64_tr_b16 a[88:89], v2 offset:2048
  ds_read_b64_tr_b16 a[90:91], v2 offset:2560
  v_exp_f32 v219, v219
  v_fmaak_f32 v220, -0.5, v216, 0xbf800000
  v_fmaak_f32 v221, -0.5, v217, 0xbf800000
  v_fmaak_f32 v222, -0.5, v218, 0xbf800000
  v_mfma_f32_32x32x16_bf16 v[16:31], v[172:175], a[172:175], v[16:31]
  ds_read_b64_tr_b16 a[92:93], v3 offset:2048
  ds_read_b64_tr_b16 a[94:95], v3 offset:2560
  v_fmaak_f32 v223, -0.5, v219, 0xbf800000
  v_fmaak_f32 v216, v216, v220, 0xbf800000
  v_fmaak_f32 v217, v217, v221, 0xbf800000
  s_waitcnt vmcnt(13)
  s_waitcnt lgkmcnt(10)
  v_mfma_f32_32x32x16_bf16 v[16:31], v[184:187], a[176:179], v[16:31]
  ds_read_b64_tr_b16 a[96:97], v2 offset:4096
  ds_read_b64_tr_b16 a[98:99], v2 offset:4608
  v_fmaak_f32 v218, v218, v222, 0xbf800000
  v_fmaak_f32 v219, v219, v223, 0xbf800000
  v_rcp_f32 v216, v216
  v_mfma_f32_32x32x16_bf16 v[16:31], v[188:191], a[180:183], v[16:31]
  ds_read_b64_tr_b16 a[100:101], v3 offset:4096
  ds_read_b64_tr_b16 a[102:103], v3 offset:4608
  v_rcp_f32 v217, v217
  v_rcp_f32 v218, v218
  s_waitcnt lgkmcnt(8)
  v_mfma_f32_32x32x16_bf16 v[16:31], v[200:203], a[184:187], v[16:31]
  ds_read_b64_tr_b16 a[104:105], v2 offset:6144
  ds_read_b64_tr_b16 a[106:107], v2 offset:6656
  v_rcp_f32 v219, v219
  v_fmac_f32 v52, v52, v216
  v_fmac_f32 v53, v53, v217
  v_fmac_f32 v54, v54, v218
  v_fmac_f32 v55, v55, v219
  v_mfma_f32_32x32x16_bf16 v[16:31], v[204:207], a[188:191], v[16:31]
  ds_read_b64_tr_b16 a[108:109], v3 offset:6144
  ds_read_b64_tr_b16 a[110:111], v3 offset:6656
  v_cvt_pk_bf16_f32 v50, v52, v53
  v_cvt_pk_bf16_f32 v51, v54, v55
  s_waitcnt vmcnt(9)
  v_mfma_f32_32x32x16_bf16 v[32:47], a[0:3], a[128:131], 0
  ds_read_b64_tr_b16 a[112:113], v2 offset:8192
  ds_read_b64_tr_b16 a[114:115], v2 offset:8704
  s_waitcnt vmcnt(2)
  v_cmp_ne_u32 vcc, s72, v252
  s_cbranch_vccnz Ls0
Lr0:
  v_mfma_f32_32x32x16_bf16 v[32:47], a[8:11], a[132:135], v[32:47]
  ds_read_b64_tr_b16 a[116:117], v3 offset:8192
  ds_read_b64_tr_b16 a[118:119], v3 offset:8704
  v_cvt_pk_bf16_f32 v16, v16, v17
  v_cvt_pk_bf16_f32 v17, v18, v19
  v_cvt_pk_bf16_f32 v18, v20, v21
  v_cvt_pk_bf16_f32 v19, v22, v23
  v_mfma_f32_32x32x16_bf16 v[32:47], a[16:19], a[160:163], v[32:47]
  ds_read_b64_tr_b16 a[120:121], v2 offset:10240
  ds_read_b64_tr_b16 a[122:123], v2 offset:10752
  buffer_store_dwordx4 v[16:19], v244, s[56:59], s36 offen offset:0 sc1
  v_mfma_f32_32x32x16_bf16 v[32:47], a[24:27], a[164:167], v[32:47]
  ds_read_b64_tr_b16 a[124:125], v3 offset:10240
  ds_read_b64_tr_b16 a[126:127], v3 offset:10752
  ds_write_b128 v237, v[48:51] offset:0
  v_mul_f32 v208, v143, v56
  v_mfma_f32_32x32x16_bf16 v[32:47], a[32:35], a[136:139], v[32:47]
  v_cvt_pk_bf16_f32 v24, v24, v25
  v_cvt_pk_bf16_f32 v25, v26, v27
  v_cvt_pk_bf16_f32 v26, v28, v29
  v_cvt_pk_bf16_f32 v27, v30, v31
  v_mul_f32 v209, v143, v57
  v_mul_f32 v210, v143, v58
  v_mul_f32 v211, v143, v59
  v_mfma_f32_32x32x16_bf16 v[32:47], a[40:43], a[140:143], v[32:47]
  buffer_store_dwordx4 v[24:27], v244, s[56:59], s36 offen offset:1024 sc1
  v_exp_f32 v208, v208
  v_mfma_f32_32x32x16_bf16 v[32:47], a[48:51], a[168:171], v[32:47]
  v_exp_f32 v209, v209
  v_exp_f32 v210, v210
  v_exp_f32 v211, v211
  v_fmaak_f32 v212, -0.5, v208, 0xbf800000
  v_mfma_f32_32x32x16_bf16 v[32:47], a[56:59], a[172:175], v[32:47]
  v_fmaak_f32 v213, -0.5, v209, 0xbf800000
  v_fmaak_f32 v214, -0.5, v210, 0xbf800000
  v_fmaak_f32 v215, -0.5, v211, 0xbf800000
  v_fmaak_f32 v208, v208, v212, 0xbf800000
  v_fmaak_f32 v209, v209, v213, 0xbf800000
  v_fmaak_f32 v210, v210, v214, 0xbf800000
  v_fmaak_f32 v211, v211, v215, 0xbf800000
  v_mfma_f32_32x32x16_bf16 v[32:47], a[64:67], a[144:147], v[32:47]
  v_rcp_f32 v208, v208
  v_rcp_f32 v209, v209
  v_rcp_f32 v210, v210
  v_mfma_f32_32x32x16_bf16 v[32:47], a[72:75], a[148:151], v[32:47]
  v_rcp_f32 v211, v211
  v_fmac_f32 v56, v56, v208
  v_fmac_f32 v57, v57, v209
  v_fmac_f32 v58, v58, v210
  v_fmac_f32 v59, v59, v211
  v_cvt_pk_bf16_f32 v56, v56, v57
  s_waitcnt lgkmcnt(1)
  v_mfma_f32_32x32x16_bf16 v[32:47], a[80:83], a[176:179], v[32:47]
  v_cvt_pk_bf16_f32 v57, v58, v59
  v_mul_f32 v216, v143, v60
  v_mul_f32 v217, v143, v61
  v_mul_f32 v218, v143, v62
  v_mul_f32 v219, v143, v63
  v_exp_f32 v216, v216
  v_mfma_f32_32x32x16_bf16 v[32:47], a[88:91], a[180:183], v[32:47]
  v_exp_f32 v217, v217
  v_exp_f32 v218, v218
  v_exp_f32 v219, v219
  v_fmaak_f32 v220, -0.5, v216, 0xbf800000
  v_mfma_f32_32x32x16_bf16 v[32:47], a[96:99], a[152:155], v[32:47]
  v_fmaak_f32 v221, -0.5, v217, 0xbf800000
  v_fmaak_f32 v222, -0.5, v218, 0xbf800000
  v_fmaak_f32 v223, -0.5, v219, 0xbf800000
  v_fmaak_f32 v216, v216, v220, 0xbf800000
  v_fmaak_f32 v217, v217, v221, 0xbf800000
  v_fmaak_f32 v218, v218, v222, 0xbf800000
  v_mfma_f32_32x32x16_bf16 v[32:47], a[104:107], a[156:159], v[32:47]
  v_fmaak_f32 v219, v219, v223, 0xbf800000
  v_rcp_f32 v216, v216
  v_rcp_f32 v217, v217
  v_rcp_f32 v218, v218
  v_mfma_f32_32x32x16_bf16 v[32:47], a[112:115], a[184:187], v[32:47]
  v_rcp_f32 v219, v219
  v_fmac_f32 v60, v60, v216
  v_fmac_f32 v61, v61, v217
  v_fmac_f32 v62, v62, v218
  v_fmac_f32 v63, v63, v219
  v_cvt_pk_bf16_f32 v58, v60, v61
  v_mfma_f32_32x32x16_bf16 v[32:47], a[120:123], a[188:191], v[32:47]
  v_cvt_pk_bf16_f32 v59, v62, v63
  v_mul_f32 v208, v143, v64
  v_mul_f32 v209, v143, v65
  v_mul_f32 v210, v143, v66
  v_mul_f32 v211, v143, v67
  v_exp_f32 v208, v208
  v_mfma_f32_32x32x16_bf16 v[16:31], a[4:7], a[128:131], 0
  ds_write_b128 v237, v[56:59] offset:1024
  v_mfma_f32_32x32x16_bf16 v[16:31], a[12:15], a[132:135], v[16:31]
  v_cvt_pk_bf16_f32 v32, v32, v33
  v_cvt_pk_bf16_f32 v33, v34, v35
  v_cvt_pk_bf16_f32 v34, v36, v37
  v_cvt_pk_bf16_f32 v35, v38, v39
  v_exp_f32 v209, v209
  v_exp_f32 v210, v210
  v_mfma_f32_32x32x16_bf16 v[16:31], a[36:39], a[136:139], v[16:31]
  buffer_store_dwordx4 v[32:35], v244, s[56:59], s35 offen offset:0 sc1
  v_exp_f32 v211, v211
  v_mfma_f32_32x32x16_bf16 v[16:31], a[44:47], a[140:143], v[16:31]
  s_waitcnt lgkmcnt(0)
  s_barrier
  v_fmaak_f32 v212, -0.5, v208, 0xbf800000
  v_fmaak_f32 v213, -0.5, v209, 0xbf800000
  v_fmaak_f32 v214, -0.5, v210, 0xbf800000
  v_fmaak_f32 v215, -0.5, v211, 0xbf800000
  v_fmaak_f32 v208, v208, v212, 0xbf800000
  v_mfma_f32_32x32x16_bf16 v[16:31], a[68:71], a[144:147], v[16:31]
  v_cvt_pk_bf16_f32 v40, v40, v41
  v_cvt_pk_bf16_f32 v41, v42, v43
  v_cvt_pk_bf16_f32 v42, v44, v45
  v_cvt_pk_bf16_f32 v43, v46, v47
  v_fmaak_f32 v209, v209, v213, 0xbf800000
  v_fmaak_f32 v210, v210, v214, 0xbf800000
  v_fmaak_f32 v211, v211, v215, 0xbf800000
  v_mfma_f32_32x32x16_bf16 v[16:31], a[76:79], a[148:151], v[16:31]
  buffer_store_dwordx4 v[40:43], v244, s[56:59], s35 offen offset:1024 sc1
  v_rcp_f32 v208, v208
  v_mfma_f32_32x32x16_bf16 v[16:31], a[100:103], a[152:155], v[16:31]
  ds_read_b128 a[192:195], v238 offset:0
  v_rcp_f32 v209, v209
  v_rcp_f32 v210, v210
  v_rcp_f32 v211, v211
  v_mfma_f32_32x32x16_bf16 v[16:31], a[108:111], a[156:159], v[16:31]
  ds_read_b128 a[196:199], v238 offset:1024
  v_fmac_f32 v64, v64, v208
  v_fmac_f32 v65, v65, v209
  v_fmac_f32 v66, v66, v210
  v_fmac_f32 v67, v67, v211
  v_cvt_pk_bf16_f32 v64, v64, v65
  v_cvt_pk_bf16_f32 v65, v66, v67
  v_mfma_f32_32x32x16_bf16 v[16:31], a[20:23], a[160:163], v[16:31]
  ds_read_b128 a[200:203], v238 offset:4096
  v_mul_f32 v216, v143, v68
  v_mul_f32 v217, v143, v69
  v_mul_f32 v218, v143, v70
  v_mul_f32 v219, v143, v71
  v_exp_f32 v216, v216
  v_mfma_f32_32x32x16_bf16 v[16:31], a[28:31], a[164:167], v[16:31]
  ds_read_b128 a[204:207], v238 offset:5120
  v_exp_f32 v217, v217
  v_exp_f32 v218, v218
  v_exp_f32 v219, v219
  v_mfma_f32_32x32x16_bf16 v[16:31], a[52:55], a[168:171], v[16:31]
  ds_read_b128 a[208:211], v238 offset:8192
  v_fmaak_f32 v220, -0.5, v216, 0xbf800000
  v_fmaak_f32 v221, -0.5, v217, 0xbf800000
  v_fmaak_f32 v222, -0.5, v218, 0xbf800000
  v_fmaak_f32 v223, -0.5, v219, 0xbf800000
  v_fmaak_f32 v216, v216, v220, 0xbf800000
  v_fmaak_f32 v217, v217, v221, 0xbf800000
  v_mfma_f32_32x32x16_bf16 v[16:31], a[60:63], a[172:175], v[16:31]
  ds_read_b128 a[212:215], v238 offset:9216
  v_fmaak_f32 v218, v218, v222, 0xbf800000
  v_fmaak_f32 v219, v219, v223, 0xbf800000
  v_rcp_f32 v216, v216
  v_rcp_f32 v217, v217
  v_mfma_f32_32x32x16_bf16 v[16:31], a[84:87], a[176:179], v[16:31]
  ds_read_b128 a[216:219], v238 offset:12288
  v_rcp_f32 v218, v218
  v_rcp_f32 v219, v219
  v_fmac_f32 v68, v68, v216
  v_fmac_f32 v69, v69, v217
  v_mfma_f32_32x32x16_bf16 v[16:31], a[92:95], a[180:183], v[16:31]
  ds_read_b128 a[220:223], v238 offset:13312
  buffer_load_dwordx4 v[96:99], v244, s[56:59], s44 offen sc1
  v_fmac_f32 v70, v70, v218
  v_fmac_f32 v71, v71, v219
  v_cvt_pk_bf16_f32 v66, v68, v69
  v_cvt_pk_bf16_f32 v67, v70, v71
  v_mfma_f32_32x32x16_bf16 v[16:31], a[116:119], a[184:187], v[16:31]
  buffer_load_dwordx4 v[100:103], v244, s[56:59], s45 offen sc1
  ds_write_b128 v237, v[64:67] offset:2048
  v_mul_f32 v208, v143, v72
  v_mfma_f32_32x32x16_bf16 v[16:31], a[124:127], a[188:191], v[16:31]
  v_mul_f32 v209, v143, v73
  v_mul_f32 v210, v143, v74
  v_mul_f32 v211, v143, v75
  v_exp_f32 v208, v208
  s_waitcnt lgkmcnt(1)
  v_mfma_f32_32x32x16_bf16 v[32:47], v[144:147], a[192:195], 0
  v_exp_f32 v209, v209
  v_exp_f32 v210, v210
  v_exp_f32 v211, v211
  v_fmaak_f32 v212, -0.5, v208, 0xbf800000
  v_mfma_f32_32x32x16_bf16 v[32:47], v[148:151], a[196:199], v[32:47]
  v_cvt_pk_bf16_f32 v16, v16, v17
  v_cvt_pk_bf16_f32 v17, v18, v19
  v_cvt_pk_bf16_f32 v18, v20, v21
  v_cvt_pk_bf16_f32 v19, v22, v23
  v_fmaak_f32 v213, -0.5, v209, 0xbf800000
  v_fmaak_f32 v214, -0.5, v210, 0xbf800000
  v_fmaak_f32 v215, -0.5, v211, 0xbf800000
  v_mfma_f32_32x32x16_bf16 v[32:47], v[160:163], a[200:203], v[32:47]
  buffer_store_dwordx4 v[16:19], v244, s[56:59], s35 offen offset:2048 sc1
  v_fmaak_f32 v208, v208, v212, 0xbf800000
  v_fmaak_f32 v209, v209, v213, 0xbf800000
  v_mfma_f32_32x32x16_bf16 v[32:47], v[164:167], a[204:207], v[32:47]
  v_fmaak_f32 v210, v210, v214, 0xbf800000
  v_fmaak_f32 v211, v211, v215, 0xbf800000
  v_rcp_f32 v208, v208
  v_rcp_f32 v209, v209
  v_mfma_f32_32x32x16_bf16 v[32:47], v[176:179], a[208:211], v[32:47]
  v_cvt_pk_bf16_f32 v24, v24, v25
  v_cvt_pk_bf16_f32 v25, v26, v27
  v_cvt_pk_bf16_f32 v26, v28, v29
  v_cvt_pk_bf16_f32 v27, v30, v31
  v_rcp_f32 v210, v210
  v_rcp_f32 v211, v211
  v_mfma_f32_32x32x16_bf16 v[32:47], v[180:183], a[212:215], v[32:47]
  buffer_store_dwordx4 v[24:27], v244, s[56:59], s35 offen offset:3072 sc1
  v_fmac_f32 v72, v72, v208
  v_fmac_f32 v73, v73, v209
  v_mfma_f32_32x32x16_bf16 v[32:47], v[192:195], a[216:219], v[32:47]
  v_fmac_f32 v74, v74, v210
  v_fmac_f32 v75, v75, v211
  v_cvt_pk_bf16_f32 v72, v72, v73
  v_cvt_pk_bf16_f32 v73, v74, v75
  v_mul_f32 v216, v143, v76
  v_mul_f32 v217, v143, v77
  v_mul_f32 v218, v143, v78
  v_mfma_f32_32x32x16_bf16 v[32:47], v[196:199], a[220:223], v[32:47]
  v_mul_f32 v219, v143, v79
  v_exp_f32 v216, v216
  v_exp_f32 v217, v217
  v_exp_f32 v218, v218
  v_mfma_f32_32x32x16_bf16 v[16:31], a[0:3], a[192:195], 0
  v_exp_f32 v219, v219
  v_fmaak_f32 v220, -0.5, v216, 0xbf800000
  v_fmaak_f32 v221, -0.5, v217, 0xbf800000
  v_fmaak_f32 v222, -0.5, v218, 0xbf800000
  v_fmaak_f32 v223, -0.5, v219, 0xbf800000
  v_fmaak_f32 v216, v216, v220, 0xbf800000
  v_mfma_f32_32x32x16_bf16 v[16:31], a[8:11], a[196:199], v[16:31]
  v_fmaak_f32 v217, v217, v221, 0xbf800000
  v_fmaak_f32 v218, v218, v222, 0xbf800000
  v_fmaak_f32 v219, v219, v223, 0xbf800000
  v_rcp_f32 v216, v216
  v_rcp_f32 v217, v217
  v_mfma_f32_32x32x16_bf16 v[16:31], a[32:35], a[200:203], v[16:31]
  v_rcp_f32 v218, v218
  v_rcp_f32 v219, v219
  v_fmac_f32 v76, v76, v216
  v_fmac_f32 v77, v77, v217
  v_fmac_f32 v78, v78, v218
  v_mfma_f32_32x32x16_bf16 v[16:31], a[40:43], a[204:207], v[16:31]
  v_fmac_f32 v79, v79, v219
  v_cvt_pk_bf16_f32 v74, v76, v77
  v_cvt_pk_bf16_f32 v75, v78, v79
  ds_write_b128 v237, v[72:75] offset:3072
  v_mfma_f32_32x32x16_bf16 v[16:31], a[64:67], a[208:211], v[16:31]
  v_mfma_f32_32x32x16_bf16 v[16:31], a[72:75], a[212:215], v[16:31]
  s_waitcnt lgkmcnt(0) vmcnt(8)
  s_barrier
  v_mfma_f32_32x32x16_bf16 v[16:31], a[96:99], a[216:219], v[16:31]
  ds_read_b128 a[224:227], v238 offset:2048
  ds_read_b128 a[228:231], v238 offset:3072
  v_mfma_f32_32x32x16_bf16 v[16:31], a[104:107], a[220:223], v[16:31]
  ds_read_b128 a[232:235], v238 offset:6144
  s_waitcnt lgkmcnt(1)
  v_mfma_f32_32x32x16_bf16 v[32:47], v[152:155], a[224:227], v[32:47]
  ds_read_b128 a[236:239], v238 offset:7168
  v_mfma_f32_32x32x16_bf16 v[32:47], v[156:159], a[228:231], v[32:47]
  ds_read_b128 a[240:243], v238 offset:10240
  ds_read_b128 a[244:247], v238 offset:11264
  s_cmp_lt_u32 s73, 2
  s_cbranch_scc0 Lw0a
  buffer_load_dwordx4 v[80:83], v244, s[56:59], s40 offen sc1
  buffer_load_dwordx4 v[84:87], v244, s[56:59], s41 offen sc1
  buffer_load_dwordx4 v[88:91], v244, s[56:59], s42 offen sc1
  buffer_load_dwordx4 v[92:95], v244, s[56:59], s43 offen sc1
Lw0a:
  s_waitcnt lgkmcnt(2)
  v_mfma_f32_32x32x16_bf16 v[32:47], v[168:171], a[232:235], v[32:47]
  ds_read_b128 a[248:251], v238 offset:14336
  v_mfma_f32_32x32x16_bf16 v[32:47], v[172:175], a[236:239], v[32:47]
  ds_read_b128 a[252:255], v238 offset:15360
  s_waitcnt lgkmcnt(2)
  v_mfma_f32_32x32x16_bf16 v[32:47], v[184:187], a[240:243], v[32:47]
  v_mfma_f32_32x32x16_bf16 v[32:47], v[188:191], a[244:247], v[32:47]
  ds_read_b128 a[128:131], v239 offset:0
  ds_read_b128 a[132:135], v239 offset:256
  ds_read_b128 a[136:139], v239 offset:2048
  s_waitcnt lgkmcnt(3)
  v_mfma_f32_32x32x16_bf16 v[32:47], v[200:203], a[248:251], v[32:47]
  ds_read_b128 a[140:143], v239 offset:2304
  ds_read_b128 a[144:147], v239 offset:24576
  v_mfma_f32_32x32x16_bf16 v[32:47], v[204:207], a[252:255], v[32:47]
  ds_read_b128 a[148:151], v239 offset:24832
  ds_read_b128 a[152:155], v239 offset:26624
  v_mfma_f32_32x32x16_bf16 v[16:31], a[16:19], a[224:227], v[16:31]
  ds_read_b128 a[156:159], v239 offset:26880
  ds_read_b128 a[160:163], v240 offset:0
  v_mfma_f32_32x32x16_bf16 v[16:31], a[24:27], a[228:231], v[16:31]
  ds_read_b128 a[164:167], v240 offset:256
  ds_read_b128 a[168:171], v240 offset:2048
  v_cvt_pk_bf16_f32 v32, v32, v33
  v_cvt_pk_bf16_f32 v33, v34, v35
  v_cvt_pk_bf16_f32 v34, v36, v37
  v_cvt_pk_bf16_f32 v35, v38, v39
  v_mfma_f32_32x32x16_bf16 v[16:31], a[48:51], a[232:235], v[16:31]
  buffer_store_dwordx4 v[32:35], v244, s[56:59], s71 offen offset:0 sc1
  ds_read_b128 a[172:175], v240 offset:2304
  ds_read_b128 a[176:179], v240 offset:24576
  v_mfma_f32_32x32x16_bf16 v[16:31], a[56:59], a[236:239], v[16:31]
  ds_read_b128 a[180:183], v240 offset:24832
  ds_read_b128 a[184:187], v240 offset:26624
  v_mfma_f32_32x32x16_bf16 v[16:31], a[80:83], a[240:243], v[16:31]
  ds_read_b128 a[188:191], v240 offset:26880
  ds_read_b64_tr_b16 v[48:49], v226 offset:0
  v_cvt_pk_bf16_f32 v40, v40, v41
  v_cvt_pk_bf16_f32 v41, v42, v43
  v_cvt_pk_bf16_f32 v42, v44, v45
  v_cvt_pk_bf16_f32 v43, v46, v47
  v_mfma_f32_32x32x16_bf16 v[16:31], a[88:91], a[244:247], v[16:31]
  buffer_store_dwordx4 v[40:43], v244, s[56:59], s71 offen offset:1024 sc1
  ds_read_b64_tr_b16 v[50:51], v226 offset:512
  ds_read_b64_tr_b16 v[52:53], v226 offset:4096
  ds_read_b64_tr_b16 v[54:55], v226 offset:4608
  v_mfma_f32_32x32x16_bf16 v[16:31], a[112:115], a[248:251], v[16:31]
  ds_read_b64_tr_b16 v[56:57], v226 offset:24576
  ds_read_b64_tr_b16 v[58:59], v226 offset:25088
  v_mfma_f32_32x32x16_bf16 v[16:31], a[120:123], a[252:255], v[16:31]
  ds_read_b64_tr_b16 v[60:61], v226 offset:28672
  ds_read_b64_tr_b16 v[62:63], v226 offset:29184
  v_mfma_f32_32x32x16_bf16 v[32:47], a[4:7], a[192:195], 0
  ds_read_b64_tr_b16 v[64:65], v227 offset:0
  ds_read_b64_tr_b16 v[66:67], v227 offset:512
  v_mfma_f32_32x32x16_bf16 v[32:47], a[12:15], a[196:199], v[32:47]
  ds_read_b64_tr_b16 v[68:69], v227 offset:4096
  ds_read_b64_tr_b16 v[70:71], v227 offset:4608
  v_cvt_pk_bf16_f32 v16, v16, v17
  v_cvt_pk_bf16_f32 v17, v18, v19
  v_cvt_pk_bf16_f32 v18, v20, v21
  v_cvt_pk_bf16_f32 v19, v22, v23
  v_mfma_f32_32x32x16_bf16 v[32:47], a[36:39], a[200:203], v[32:47]
  buffer_store_dwordx4 v[16:19], v244, s[56:59], s70 offen offset:0 sc1
  ds_read_b64_tr_b16 v[72:73], v227 offset:24576
  ds_read_b64_tr_b16 v[74:75], v227 offset:25088
  v_mfma_f32_32x32x16_bf16 v[32:47], a[44:47], a[204:207], v[32:47]
  ds_read_b64_tr_b16 v[76:77], v227 offset:28672
  ds_read_b64_tr_b16 v[78:79], v227 offset:29184
  v_mfma_f32_32x32x16_bf16 v[32:47], a[68:71], a[208:211], v[32:47]
  ds_read_b64_tr_b16 v[128:129], v242 offset:0
  ds_read_b64_tr_b16 v[130:131], v242 offset:512
  ds_read_b128 v[144:147], v241 offset:0
  s_cmp_lt_u32 s73, 2
  s_cbranch_scc1 Lw0b
  buffer_load_dwordx4 v[80:83], v244, s[56:59], s40 offen sc1
  buffer_load_dwordx4 v[84:87], v244, s[56:59], s41 offen sc1
  buffer_load_dwordx4 v[88:91], v244, s[56:59], s42 offen sc1
  buffer_load_dwordx4 v[92:95], v244, s[56:59], s43 offen sc1
Lw0b:
  v_cvt_pk_bf16_f32 v24, v24, v25
  v_cvt_pk_bf16_f32 v25, v26, v27
  v_cvt_pk_bf16_f32 v26, v28, v29
  v_cvt_pk_bf16_f32 v27, v30, v31
  v_mfma_f32_32x32x16_bf16 v[32:47], a[76:79], a[212:215], v[32:47]
  buffer_store_dwordx4 v[24:27], v244, s[56:59], s70 offen offset:1024 sc1
  ds_read_b64_tr_b16 v[132:133], v243 offset:0
  ds_read_b64_tr_b16 v[134:135], v243 offset:512
  ds_read_b128 v[148:151], v241 offset:256
  v_mfma_f32_32x32x16_bf16 v[32:47], a[100:103], a[216:219], v[32:47]
  ds_read_b128 v[152:155], v241 offset:2048
  v_mfma_f32_32x32x16_bf16 v[32:47], a[108:111], a[220:223], v[32:47]
  ds_read_b128 v[156:159], v241 offset:2304
  v_mfma_f32_32x32x16_bf16 v[32:47], a[20:23], a[224:227], v[32:47]
  ds_read_b128 v[160:163], v241 offset:4096
  v_mfma_f32_32x32x16_bf16 v[32:47], a[28:31], a[228:231], v[32:47]
  ds_read_b128 v[164:167], v241 offset:4352
  v_mfma_f32_32x32x16_bf16 v[32:47], a[52:55], a[232:235], v[32:47]
  ds_read_b128 v[168:171], v241 offset:6144
  v_mfma_f32_32x32x16_bf16 v[32:47], a[60:63], a[236:239], v[32:47]
  ds_read_b128 v[172:175], v241 offset:6400
  v_mfma_f32_32x32x16_bf16 v[32:47], a[84:87], a[240:243], v[32:47]
  ds_read_b128 v[176:179], v241 offset:8192
  v_mfma_f32_32x32x16_bf16 v[32:47], a[92:95], a[244:247], v[32:47]
  ds_read_b128 v[180:183], v241 offset:8448
  v_mfma_f32_32x32x16_bf16 v[32:47], a[116:119], a[248:251], v[32:47]
  ds_read_b128 v[184:187], v241 offset:10240
  v_mfma_f32_32x32x16_bf16 v[32:47], a[124:127], a[252:255], v[32:47]
  ds_read_b128 v[188:191], v241 offset:10496
  s_waitcnt lgkmcnt(11)
  v_mfma_f32_16x16x32_bf16 v[16:19], v[48:51], a[128:131], 0
  ds_read_b128 v[192:195], v241 offset:12288
  v_mfma_f32_16x16x32_bf16 v[20:23], v[48:51], a[132:135], 0
  ds_read_b128 v[196:199], v241 offset:12544
  v_mfma_f32_16x16x32_bf16 v[16:19], v[52:55], a[136:139], v[16:19]
  ds_read_b128 v[200:203], v241 offset:14336
  v_cvt_pk_bf16_f32 v32, v32, v33
  v_cvt_pk_bf16_f32 v33, v34, v35
  v_mfma_f32_16x16x32_bf16 v[20:23], v[52:55], a[140:143], v[20:23]
  ds_read_b128 v[204:207], v241 offset:14592
  v_cvt_pk_bf16_f32 v34, v36, v37
  v_cvt_pk_bf16_f32 v35, v38, v39
  v_mfma_f32_16x16x32_bf16 v[16:19], v[56:59], a[144:147], v[16:19]
  buffer_store_dwordx4 v[32:35], v244, s[56:59], s70 offen offset:2048 sc1
  v_cvt_pk_bf16_f32 v40, v40, v41
  v_cvt_pk_bf16_f32 v41, v42, v43
  v_mfma_f32_16x16x32_bf16 v[20:23], v[56:59], a[148:151], v[20:23]
  v_cvt_pk_bf16_f32 v42, v44, v45
  v_cvt_pk_bf16_f32 v43, v46, v47
  v_mfma_f32_16x16x32_bf16 v[16:19], v[60:63], a[152:155], v[16:19]
  buffer_store_dwordx4 v[40:43], v244, s[56:59], s70 offen offset:3072 sc1
  v_mfma_f32_16x16x32_bf16 v[20:23], v[60:63], a[156:159], v[20:23]
  v_mfma_f32_16x16x32_bf16 v[16:19], v[64:67], a[160:163], v[16:19]
  v_mfma_f32_16x16x32_bf16 v[20:23], v[64:67], a[164:167], v[20:23]
  v_mfma_f32_16x16x32_bf16 v[16:19], v[68:71], a[168:171], v[16:19]
  v_mfma_f32_16x16x32_bf16 v[20:23], v[68:71], a[172:175], v[20:23]
  v_mfma_f32_16x16x32_bf16 v[16:19], v[72:75], a[176:179], v[16:19]
  v_mfma_f32_16x16x32_bf16 v[20:23], v[72:75], a[180:183], v[20:23]
  v_mfma_f32_16x16x32_bf16 v[16:19], v[76:79], a[184:187], v[16:19]
  v_mfma_f32_16x16x32_bf16 v[20:23], v[76:79], a[188:191], v[20:23]
  s_waitcnt lgkmcnt(0)
  v_mfma_f32_16x16x32_bf16 v[24:27], v[48:51], v[144:147], 0
  v_mfma_f32_16x16x32_bf16 v[28:31], v[48:51], v[148:151], 0
  v_mfma_f32_16x16x32_bf16 v[24:27], v[52:55], v[152:155], v[24:27]
  v_mfma_f32_16x16x32_bf16 v[28:31], v[52:55], v[156:159], v[28:31]
  v_mfma_f32_16x16x32_bf16 v[24:27], v[56:59], v[160:163], v[24:27]
  v_mfma_f32_16x16x32_bf16 v[28:31], v[56:59], v[164:167], v[28:31]
  v_mfma_f32_16x16x32_bf16 v[24:27], v[60:63], v[168:171], v[24:27]
  v_mfma_f32_16x16x32_bf16 v[28:31], v[60:63], v[172:175], v[28:31]
  v_mfma_f32_16x16x32_bf16 v[24:27], v[64:67], v[176:179], v[24:27]
  v_mfma_f32_16x16x32_bf16 v[28:31], v[64:67], v[180:183], v[28:31]
  v_mfma_f32_16x16x32_bf16 v[24:27], v[68:71], v[184:187], v[24:27]
  v_mfma_f32_16x16x32_bf16 v[28:31], v[68:71], v[188:191], v[28:31]
  v_mfma_f32_16x16x32_bf16 v[24:27], v[72:75], v[192:195], v[24:27]
  v_mfma_f32_16x16x32_bf16 v[28:31], v[72:75], v[196:199], v[28:31]
  v_mfma_f32_16x16x32_bf16 v[24:27], v[76:79], v[200:203], v[24:27]
  v_mfma_f32_16x16x32_bf16 v[28:31], v[76:79], v[204:207], v[28:31]
  v_lshrrev_b32 v64, 4, v1
  v_bfe_u32 v65, v1, 2, 2
  v_cmp_eq_u32 vcc, v64, v65
  v_and_b32 v64, 1, v1
  v_lshlrev_b32 v64, 4, v64
  v_mov_b32 v65, 0x3f80
  v_lshlrev_b32 v64, v64, v65
  v_cndmask_b32 v64, 0, v64, vcc
  v_and_b32 v65, 2, v1
  v_cmp_eq_u32 vcc, 0, v65
  s_nop 1
  v_cndmask_b32 v216, 0, v64, vcc
  v_cndmask_b32 v217, v64, 0, vcc
  v_mov_b32 v218, 0
  v_mov_b32 v219, 0
  v_mov_b32 v220, v216
  v_mov_b32 v221, v217
  v_permlane16_swap_b32 v16, v20
  v_permlane16_swap_b32 v17, v21
  v_permlane16_swap_b32 v18, v22
  v_permlane16_swap_b32 v19, v23
  v_mov_b32 v64, v16
  v_mov_b32 v65, v17
  v_mov_b32 v66, v18
  v_mov_b32 v67, v19
  v_mov_b32 v68, v20
  v_mov_b32 v69, v21
  v_mov_b32 v70, v22
  v_mov_b32 v71, v23
  v_lshlrev_b32 v48, 16, v128
  v_and_b32 v49, s79, v128
  v_lshlrev_b32 v50, 16, v129
  v_and_b32 v51, s79, v129
  v_lshlrev_b32 v52, 16, v130
  v_and_b32 v53, s79, v130
  v_lshlrev_b32 v54, 16, v131
  v_and_b32 v55, s79, v131
  s_waitcnt vmcnt(6)
  v_mfma_f32_16x16x32_bf16 v[16:19], v[216:219], v[80:83], v[64:67]
  v_xor_b32 v72, s72, v80
  v_mfma_f32_16x16x32_bf16 v[20:23], v[218:221], v[80:83], v[68:71]
  s_waitcnt vmcnt(5)
  v_mfma_f32_16x16x32_bf16 v[16:19], v[216:219], v[84:87], v[16:19]
  v_xor_b32 v74, s72, v84
  v_mfma_f32_16x16x32_bf16 v[20:23], v[218:221], v[84:87], v[20:23]
  s_waitcnt vmcnt(4)
  v_mfma_f32_16x16x32_bf16 v[16:19], v[216:219], v[88:91], v[16:19]
  v_xor_b32 v73, s72, v88
  v_mfma_f32_16x16x32_bf16 v[20:23], v[218:221], v[88:91], v[20:23]
  v_min3_u32 v72, v73, v74, v72
  s_waitcnt vmcnt(3)
Lpg5:
  s_cbranch_execz Lpgr_p0
  v_mfma_f32_16x16x32_bf16 v[16:19], v[216:219], v[92:95], v[16:19]
  v_xor_b32 v74, s72, v92
  v_mfma_f32_16x16x32_bf16 v[20:23], v[218:221], v[92:95], v[20:23]
  v_mfma_f32_16x16x32_bf16 v[16:19], v[216:219], v[96:99], v[16:19]
  v_xor_b32 v73, s72, v96
  v_mfma_f32_16x16x32_bf16 v[20:23], v[218:221], v[96:99], v[20:23]
  v_min3_u32 v72, v73, v74, v72
  v_mfma_f32_16x16x32_bf16 v[16:19], v[216:219], v[100:103], v[16:19]
  v_xor_b32 v74, s72, v100
  v_mfma_f32_16x16x32_bf16 v[20:23], v[218:221], v[100:103], v[20:23]
  v_min_u32 v72, v74, v72
  v_cmp_eq_u32 vcc, 0, v72
  s_cbranch_vccnz Lq0
Lq0y:
  s_nop 0
  v_fma_f32 v16, v140, v16, v48
  v_fma_f32 v17, v140, v17, v49
  v_fma_f32 v18, v140, v18, v50
  v_fma_f32 v19, v140, v19, v51
  v_fma_f32 v20, v140, v20, v52
  v_fma_f32 v21, v140, v21, v53
  v_fma_f32 v22, v140, v22, v54
  v_fma_f32 v23, v140, v23, v55
  v_cvt_pk_bf16_f32 v208, v16, v17
  v_cvt_pk_bf16_f32 v209, v18, v19
  v_cvt_pk_bf16_f32 v210, v20, v21
  v_cvt_pk_bf16_f32 v211, v22, v23
  s_add_u32 s83, s46, 0
  buffer_store_dwordx4 v[208:211], v247, s[60:63], s83 offen
  v_permlane16_swap_b32 v24, v28
  v_permlane16_swap_b32 v25, v29
  v_permlane16_swap_b32 v26, v30
  v_permlane16_swap_b32 v27, v31
  v_mov_b32 v64, v24
  v_mov_b32 v65, v25
  v_mov_b32 v66, v26
  v_mov_b32 v67, v27
  v_mov_b32 v68, v28
  v_mov_b32 v69, v29
  v_mov_b32 v70, v30
  v_mov_b32 v71, v31
  v_lshlrev_b32 v56, 16, v132
  v_and_b32 v57, s79, v132
  v_lshlrev_b32 v58, 16, v133
  v_and_b32 v59, s79, v133
  v_lshlrev_b32 v60, 16, v134
  v_and_b32 v61, s79, v134
  v_lshlrev_b32 v62, 16, v135
  v_and_b32 v63, s79, v135
  s_waitcnt vmcnt(1)
  buffer_load_dwordx4 v[104:107], v244, s[56:59], s64 offen sc1
  buffer_load_dwordx4 v[108:111], v244, s[56:59], s65 offen sc1
  buffer_load_dwordx4 v[112:115], v244, s[56:59], s66 offen sc1
  buffer_load_dwordx4 v[116:119], v244, s[56:59], s67 offen sc1
  buffer_load_dwordx4 v[120:123], v244, s[56:59], s68 offen sc1
  buffer_load_dwordx4 v[124:127], v244, s[56:59], s69 offen sc1
  s_waitcnt vmcnt(5)
  v_mfma_f32_16x16x32_bf16 v[24:27], v[216:219], v[104:107], v[64:67]
  v_xor_b32 v73, s72, v104
  v_mfma_f32_16x16x32_bf16 v[28:31], v[218:221], v[104:107], v[68:71]
  v_xor_b32 v74, s72, v107
  v_min_u32 v72, v73, v74
  s_waitcnt vmcnt(4)
  v_mfma_f32_16x16x32_bf16 v[24:27], v[216:219], v[108:111], v[24:27]
  v_xor_b32 v73, s72, v108
  v_mfma_f32_16x16x32_bf16 v[28:31], v[218:221], v[108:111], v[28:31]
  v_xor_b32 v74, s72, v111
  v_min3_u32 v72, v73, v74, v72
  s_waitcnt vmcnt(3)
  v_mfma_f32_16x16x32_bf16 v[24:27], v[216:219], v[112:115], v[24:27]
  v_xor_b32 v73, s72, v112
  v_mfma_f32_16x16x32_bf16 v[28:31], v[218:221], v[112:115], v[28:31]
  v_xor_b32 v74, s72, v115
  v_min3_u32 v72, v73, v74, v72
  s_waitcnt vmcnt(2)
  v_mfma_f32_16x16x32_bf16 v[24:27], v[216:219], v[116:119], v[24:27]
  v_xor_b32 v73, s72, v116
  v_mfma_f32_16x16x32_bf16 v[28:31], v[218:221], v[116:119], v[28:31]
  v_xor_b32 v74, s72, v119
  v_min3_u32 v72, v73, v74, v72
  s_waitcnt vmcnt(1)
  v_mfma_f32_16x16x32_bf16 v[24:27], v[216:219], v[120:123], v[24:27]
  v_xor_b32 v73, s72, v120
  v_mfma_f32_16x16x32_bf16 v[28:31], v[218:221], v[120:123], v[28:31]
  v_xor_b32 v74, s72, v123
  v_min3_u32 v72, v73, v74, v72
  s_waitcnt vmcnt(0)
  v_mfma_f32_16x16x32_bf16 v[24:27], v[216:219], v[124:127], v[24:27]
  v_xor_b32 v73, s72, v124
  v_mfma_f32_16x16x32_bf16 v[28:31], v[218:221], v[124:127], v[28:31]
  v_xor_b32 v74, s72, v127
  v_min3_u32 v72, v73, v74, v72
  v_cmp_eq_u32 vcc, 0, v72
  s_cbranch_vccnz Lq1
Lq1y:
  v_fma_f32 v24, v142, v24, v56
  v_fma_f32 v25, v142, v25, v57
  v_fma_f32 v26, v142, v26, v58
  v_fma_f32 v27, v142, v27, v59
  v_fma_f32 v28, v142, v28, v60
  v_fma_f32 v29, v142, v29, v61
  v_fma_f32 v30, v142, v30, v62
  v_fma_f32 v31, v142, v31, v63
  v_cvt_pk_bf16_f32 v212, v24, v25
  v_cvt_pk_bf16_f32 v213, v26, v27
  v_cvt_pk_bf16_f32 v214, v28, v29
  v_cvt_pk_bf16_f32 v215, v30, v31
  s_add_u32 s83, s46, 28672
  buffer_store_dwordx4 v[212:215], v247, s[60:63], s83 offen
  s_cmp_lg_u32 s2, 0
  s_cbranch_scc1 Lts
  v_mov_b32 v11, s72
  v_mov_b32 v12, 0
  v_cmp_eq_u32 vcc, 0, v0
  s_and_saveexec_b64 s[92:93], vcc
  s_cbranch_execz Lts
  buffer_store_dword v11, v12, s[56:59], 0 offen
Lts:
  s_endpgm
Lstretry:
  s_mov_b32 s84, 200000
Lstretry1:
  buffer_load_dwordx4 v[176:179], v253, s[56:59], 0 offen offset:0 sc1
  buffer_load_dwordx4 v[180:183], v253, s[56:59], 0 offen offset:16 sc1
  buffer_load_dwordx4 v[184:187], v253, s[56:59], 0 offen offset:2048 sc1
  buffer_load_dwordx4 v[188:191], v253, s[56:59], 0 offen offset:2064 sc1
  buffer_load_dwordx4 v[192:195], v253, s[56:59], s88 offen offset:0 sc1
  buffer_load_dwordx4 v[196:199], v253, s[56:59], s88 offen offset:16 sc1
  buffer_load_dwordx4 v[200:203], v253, s[56:59], s88 offen offset:2048 sc1
  buffer_load_dwordx4 v[204:207], v253, s[56:59], s88 offen offset:2064 sc1
  s_sub_u32 s84, s84, 1
  s_cbranch_scc1 Lstretry2
  s_waitcnt vmcnt(0)
  v_xor_b32 v12, s72, v179
  v_bitop3_b32 v12, v12, v183, s72 bitop3:0xf6
  v_bitop3_b32 v12, v12, v187, s72 bitop3:0xf6
  v_bitop3_b32 v12, v12, v191, s72 bitop3:0xf6
  v_bitop3_b32 v12, v12, v195, s72 bitop3:0xf6
  v_bitop3_b32 v12, v12, v199, s72 bitop3:0xf6
  v_bitop3_b32 v12, v12, v203, s72 bitop3:0xf6
  v_bitop3_b32 v12, v12, v207, s72 bitop3:0xf6
  v_cmp_ne_u32 vcc, 0, v12
  s_cbranch_vccnz Lstretry1
Lstretry2:
  s_waitcnt vmcnt(0)
  s_branch Lstok
Lcs:
  s_mov_b32 s84, 200000
Lcsr:
  buffer_load_dwordx4 v[48:51], v52, s[56:59], 0 offen sc1
  s_sub_u32 s84, s84, 1
  s_cbranch_scc1 Lcsx
  s_waitcnt vmcnt(0)
  v_cmp_ne_u32 vcc, s72, v51
  s_cbranch_vccnz Lcsr
  s_branch Lcsx
Lp2:
  s_mov_b32 s84, 200000
Lp2r:
  buffer_load_dword v229, v228, s[56:59], 0 offen sc1
  s_sub_u32 s84, s84, 1
  s_cbranch_scc1 Lp2x
  s_waitcnt vmcnt(0)
  v_cmp_ne_u32 vcc, s72, v229
  s_cbranch_vccnz Lp2r
  s_branch Lp2x
Ls0:
  s_mov_b32 s84, 200000
Ls0r:
  buffer_load_dword v252, v246, s[56:59], 0 offen offset:0 sc1
  s_sub_u32 s84, s84, 1
  s_cbranch_scc1 Lr0
  s_waitcnt vmcnt(0)
  v_cmp_ne_u32 vcc, s72, v252
  s_cbranch_vccnz Ls0r
  s_branch Lr0
Lq0:
  s_mov_b32 s84, 200000
Lq0r:
  s_mov_b32 s85, 0
  v_cmp_eq_u32 vcc, s72, v80
  s_cbranch_vccz Lq0k0
  buffer_load_dwordx4 v[80:83], v244, s[56:59], s40 offen sc1
  s_mov_b32 s85, 1
Lq0k0:
  v_cmp_eq_u32 vcc, s72, v84
  s_cbranch_vccz Lq0k1
  buffer_load_dwordx4 v[84:87], v244, s[56:59], s41 offen sc1
  s_mov_b32 s85, 1
Lq0k1:
  v_cmp_eq_u32 vcc, s72, v88
  s_cbranch_vccz Lq0k2
  buffer_load_dwordx4 v[88:91], v244, s[56:59], s42 offen sc1
  s_mov_b32 s85, 1
Lq0k2:
  v_cmp_eq_u32 vcc, s72, v92
  s_cbranch_vccz Lq0k3
  buffer_load_dwordx4 v[92:95], v244, s[56:59], s43 offen sc1
  s_mov_b32 s85, 1
Lq0k3:
  v_cmp_eq_u32 vcc, s72, v96
  s_cbranch_vccz Lq0k4
  buffer_load_dwordx4 v[96:99], v244, s[56:59], s44 offen sc1
  s_mov_b32 s85, 1
Lq0k4:
  v_cmp_eq_u32 vcc, s72, v100
  s_cbranch_vccz Lq0k5
  buffer_load_dwordx4 v[100:103], v244, s[56:59], s45 offen sc1
  s_mov_b32 s85, 1
Lq0k5:
  s_cmp_eq_u32 s85, 0
  s_cbranch_scc1 Lq0x
  s_waitcnt vmcnt(0)
  s_sub_u32 s84, s84, 1
  s_cbranch_scc0 Lq0r
Lq0x:
  v_mfma_f32_16x16x32_bf16 v[16:19], v[216:219], v[80:83], v[64:67]
  v_mfma_f32_16x16x32_bf16 v[20:23], v[218:221], v[80:83], v[68:71]
  v_mfma_f32_16x16x32_bf16 v[16:19], v[216:219], v[84:87], v[16:19]
  v_mfma_f32_16x16x32_bf16 v[20:23], v[218:221], v[84:87], v[20:23]
  v_mfma_f32_16x16x32_bf16 v[16:19], v[216:219], v[88:91], v[16:19]
  v_mfma_f32_16x16x32_bf16 v[20:23], v[218:221], v[88:91], v[20:23]
  v_mfma_f32_16x16x32_bf16 v[16:19], v[216:219], v[92:95], v[16:19]
  v_mfma_f32_16x16x32_bf16 v[20:23], v[218:221], v[92:95], v[20:23]
  v_mfma_f32_16x16x32_bf16 v[16:19], v[216:219], v[96:99], v[16:19]
  v_mfma_f32_16x16x32_bf16 v[20:23], v[218:221], v[96:99], v[20:23]
  v_mfma_f32_16x16x32_bf16 v[16:19], v[216:219], v[100:103], v[16:19]
  v_mfma_f32_16x16x32_bf16 v[20:23], v[218:221], v[100:103], v[20:23]
  s_nop 7
  s_nop 7
  s_branch Lq0y
Lq1:
  s_mov_b32 s84, 200000
Lq1r:
  s_mov_b32 s85, 0
  v_cmp_eq_u32 vcc, s72, v104
  v_cmp_eq_u32 s[92:93], s72, v107
  s_or_b64 vcc, vcc, s[92:93]
  s_cbranch_scc0 Lq1k0
  buffer_load_dwordx4 v[104:107], v244, s[56:59], s64 offen sc1
  s_mov_b32 s85, 1
Lq1k0:
  v_cmp_eq_u32 vcc, s72, v108
  v_cmp_eq_u32 s[92:93], s72, v111
  s_or_b64 vcc, vcc, s[92:93]
  s_cbranch_scc0 Lq1k1
  buffer_load_dwordx4 v[108:111], v244, s[56:59], s65 offen sc1
  s_mov_b32 s85, 1
Lq1k1:
  v_cmp_eq_u32 vcc, s72, v112
  v_cmp_eq_u32 s[92:93], s72, v115
  s_or_b64 vcc, vcc, s[92:93]
  s_cbranch_scc0 Lq1k2
  buffer_load_dwordx4 v[112:115], v244, s[56:59], s66 offen sc1
  s_mov_b32 s85, 1
Lq1k2:
  v_cmp_eq_u32 vcc, s72, v116
  v_cmp_eq_u32 s[92:93], s72, v119
  s_or_b64 vcc, vcc, s[92:93]
  s_cbranch_scc0 Lq1k3
  buffer_load_dwordx4 v[116:119], v244, s[56:59], s67 offen sc1
  s_mov_b32 s85, 1
Lq1k3:
  v_cmp_eq_u32 vcc, s72, v120
  v_cmp_eq_u32 s[92:93], s72, v123
  s_or_b64 vcc, vcc, s[92:93]
  s_cbranch_scc0 Lq1k4
  buffer_load_dwordx4 v[120:123], v244, s[56:59], s68 offen sc1
  s_mov_b32 s85, 1
Lq1k4:
  v_cmp_eq_u32 vcc, s72, v124
  v_cmp_eq_u32 s[92:93], s72, v127
  s_or_b64 vcc, vcc, s[92:93]
  s_cbranch_scc0 Lq1k5
  buffer_load_dwordx4 v[124:127], v244, s[56:59], s69 offen sc1
  s_mov_b32 s85, 1
Lq1k5:
  s_cmp_eq_u32 s85, 0
  s_cbranch_scc1 Lq1x
  s_waitcnt vmcnt(0)
  s_sub_u32 s84, s84, 1
  s_cbranch_scc0 Lq1r
Lq1x:
  v_mfma_f32_16x16x32_bf16 v[24:27], v[216:219], v[104:107], v[64:67]
  v_mfma_f32_16x16x32_bf16 v[28:31], v[218:221], v[104:107], v[68:71]
  v_mfma_f32_16x16x32_bf16 v[24:27], v[216:219], v[108:111], v[24:27]
  v_mfma_f32_16x16x32_bf16 v[28:31], v[218:221], v[108:111], v[28:31]
  v_mfma_f32_16x16x32_bf16 v[24:27], v[216:219], v[112:115], v[24:27]
  v_mfma_f32_16x16x32_bf16 v[28:31], v[218:221], v[112:115], v[28:31]
  v_mfma_f32_16x16x32_bf16 v[24:27], v[216:219], v[116:119], v[24:27]
  v_mfma_f32_16x16x32_bf16 v[28:31], v[218:221], v[116:119], v[28:31]
  v_mfma_f32_16x16x32_bf16 v[24:27], v[216:219], v[120:123], v[24:27]
  v_mfma_f32_16x16x32_bf16 v[28:31], v[218:221], v[120:123], v[28:31]
  v_mfma_f32_16x16x32_bf16 v[24:27], v[216:219], v[124:127], v[24:27]
  v_mfma_f32_16x16x32_bf16 v[28:31], v[218:221], v[124:127], v[28:31]
  s_nop 7
  s_nop 7
  s_branch Lq1y
Lhelper:
  s_sub_u32 s75, s2, 224
  s_mul_i32 s85, s75, 57344
  v_lshrrev_b32 v11, 2, v0
  v_mul_u32_u24 v11, 896, v11
  v_and_b32 v12, 3, v0
  v_lshl_add_u32 v16, v12, 4, v11
  s_waitcnt lgkmcnt(0)
  s_load_dwordx2 s[48:49], s[0:1], 56
  s_load_dwordx2 s[52:53], s[0:1], 72
  s_load_dword s72, s[56:57], 0
  s_lshl_b32 s86, s75, 2
  s_add_u32 s86, s86, s73
  s_mul_i32 s86, s86, 12544
  v_lshlrev_b32 v100, 4, v1
  v_add_u32 v100, s86, v100
  buffer_load_dwordx4 v[20:23], v16, s[32:35], s85 offen offset:0
  buffer_load_dwordx4 v[24:27], v16, s[32:35], s85 offen offset:64
  buffer_load_dwordx4 v[28:31], v16, s[32:35], s85 offen offset:128
  buffer_load_dwordx4 v[32:35], v16, s[32:35], s85 offen offset:192
  buffer_load_dwordx4 v[36:39], v16, s[32:35], s85 offen offset:256
  buffer_load_dwordx4 v[40:43], v16, s[32:35], s85 offen offset:320
  buffer_load_dwordx4 v[44:47], v16, s[32:35], s85 offen offset:384
  buffer_load_dwordx4 v[48:51], v16, s[32:35], s85 offen offset:448
  buffer_load_dwordx4 v[52:55], v16, s[32:35], s85 offen offset:512
  buffer_load_dwordx4 v[56:59], v16, s[32:35], s85 offen offset:576
  buffer_load_dwordx4 v[60:63], v16, s[32:35], s85 offen offset:640
  buffer_load_dwordx4 v[64:67], v16, s[32:35], s85 offen offset:704
  buffer_load_dwordx4 v[68:71], v16, s[32:35], s85 offen offset:768
  buffer_load_dwordx4 v[72:75], v16, s[32:35], s85 offen offset:832
  s_and_b32 s85, s75, 1
  s_mul_i32 s85, s85, 3
  s_lshr_b32 s77, s75, 3
  s_add_u32 s77, s77, s85
  s_mul_i32 s97, s77, 229376
  s_mul_i32 s96, s73, 57344
  s_add_u32 s96, s96, s97
  s_add_u32 s96, s96, 512
  s_lshl_b32 s85, s73, 7
  s_add_u32 s97, s97, s85
  v_lshrrev_b32 v11, 3, v1
  v_mul_u32_u24 v11, 896, v11
  v_and_b32 v12, 7, v1
  v_lshl_add_u32 v18, v12, 4, v11
  v_lshlrev_b32 v19, 4, v1
  v_mov_b32 v92, -1
  v_mov_b32 v93, -1
  v_mov_b32 v94, -1
  v_mov_b32 v95, -1
  s_waitcnt lgkmcnt(0)
  s_add_u32 s72, s72, 2654435761
  v_mov_b32 v92, s72
  v_mov_b32 v93, s72
  v_mov_b32 v94, s72
  v_mov_b32 v95, s72
  v_mov_b32 v80, 0
  v_mov_b32 v81, 0
  v_mov_b32 v82, 0
  v_mov_b32 v83, 0
  v_mov_b32 v84, 0x3f803f80
  s_lshl_b32 s85, s75, 9
  s_add_u32 s85, s85, 327680
  v_lshlrev_b32 v17, 1, v0
  v_add_u32 v17, s85, v17
  s_waitcnt vmcnt(13)
  v_dot2_f32_bf16 v80, v20, v84, v80
  v_dot2_f32_bf16 v82, v20, v20, v82
  v_dot2_f32_bf16 v81, v21, v84, v81
  v_dot2_f32_bf16 v83, v21, v21, v83
  v_dot2_f32_bf16 v80, v22, v84, v80
  v_dot2_f32_bf16 v82, v22, v22, v82
  v_dot2_f32_bf16 v81, v23, v84, v81
  v_dot2_f32_bf16 v83, v23, v23, v83
  s_waitcnt vmcnt(12)
  v_dot2_f32_bf16 v80, v24, v84, v80
  v_dot2_f32_bf16 v82, v24, v24, v82
  v_dot2_f32_bf16 v81, v25, v84, v81
  v_dot2_f32_bf16 v83, v25, v25, v83
  v_dot2_f32_bf16 v80, v26, v84, v80
  v_dot2_f32_bf16 v82, v26, v26, v82
  v_dot2_f32_bf16 v81, v27, v84, v81
  v_dot2_f32_bf16 v83, v27, v27, v83
  s_waitcnt vmcnt(11)
  v_dot2_f32_bf16 v80, v28, v84, v80
  v_dot2_f32_bf16 v82, v28, v28, v82
  v_dot2_f32_bf16 v81, v29, v84, v81
  v_dot2_f32_bf16 v83, v29, v29, v83
  v_dot2_f32_bf16 v80, v30, v84, v80
  v_dot2_f32_bf16 v82, v30, v30, v82
  v_dot2_f32_bf16 v81, v31, v84, v81
  v_dot2_f32_bf16 v83, v31, v31, v83
  s_waitcnt vmcnt(10)
  v_dot2_f32_bf16 v80, v32, v84, v80
  v_dot2_f32_bf16 v82, v32, v32, v82
  v_dot2_f32_bf16 v81, v33, v84, v81
  v_dot2_f32_bf16 v83, v33, v33, v83
  v_dot2_f32_bf16 v80, v34, v84, v80
  v_dot2_f32_bf16 v82, v34, v34, v82
  v_dot2_f32_bf16 v81, v35, v84, v81
  v_dot2_f32_bf16 v83, v35, v35, v83
  s_waitcnt vmcnt(9)
  v_dot2_f32_bf16 v80, v36, v84, v80
  v_dot2_f32_bf16 v82, v36, v36, v82
  v_dot2_f32_bf16 v81, v37, v84, v81
  v_dot2_f32_bf16 v83, v37, v37, v83
  v_dot2_f32_bf16 v80, v38, v84, v80
  v_dot2_f32_bf16 v82, v38, v38, v82
  v_dot2_f32_bf16 v81, v39, v84, v81
  v_dot2_f32_bf16 v83, v39, v39, v83
  s_waitcnt vmcnt(8)
  v_dot2_f32_bf16 v80, v40, v84, v80
  v_dot2_f32_bf16 v82, v40, v40, v82
  v_dot2_f32_bf16 v81, v41, v84, v81
  v_dot2_f32_bf16 v83, v41, v41, v83
  v_dot2_f32_bf16 v80, v42, v84, v80
  v_dot2_f32_bf16 v82, v42, v42, v82
  v_dot2_f32_bf16 v81, v43, v84, v81
  v_dot2_f32_bf16 v83, v43, v43, v83
  s_waitcnt vmcnt(7)
  v_dot2_f32_bf16 v80, v44, v84, v80
  v_dot2_f32_bf16 v82, v44, v44, v82
  v_dot2_f32_bf16 v81, v45, v84, v81
  v_dot2_f32_bf16 v83, v45, v45, v83
  v_dot2_f32_bf16 v80, v46, v84, v80
  v_dot2_f32_bf16 v82, v46, v46, v82
  v_dot2_f32_bf16 v81, v47, v84, v81
  v_dot2_f32_bf16 v83, v47, v47, v83
  s_waitcnt vmcnt(6)
  v_dot2_f32_bf16 v80, v48, v84, v80
  v_dot2_f32_bf16 v82, v48, v48, v82
  v_dot2_f32_bf16 v81, v49, v84, v81
  v_dot2_f32_bf16 v83, v49, v49, v83
  v_dot2_f32_bf16 v80, v50, v84, v80
  v_dot2_f32_bf16 v82, v50, v50, v82
  v_dot2_f32_bf16 v81, v51, v84, v81
  v_dot2_f32_bf16 v83, v51, v51, v83
  s_waitcnt vmcnt(5)
  v_dot2_f32_bf16 v80, v52, v84, v80
  v_dot2_f32_bf16 v82, v52, v52, v82
  v_dot2_f32_bf16 v81, v53, v84, v81
  v_dot2_f32_bf16 v83, v53, v53, v83
  v_dot2_f32_bf16 v80, v54, v84, v80
  v_dot2_f32_bf16 v82, v54, v54, v82
  v_dot2_f32_bf16 v81, v55, v84, v81
  v_dot2_f32_bf16 v83, v55, v55, v83
  s_waitcnt vmcnt(4)
  v_dot2_f32_bf16 v80, v56, v84, v80
  v_dot2_f32_bf16 v82, v56, v56, v82
  v_dot2_f32_bf16 v81, v57, v84, v81
  v_dot2_f32_bf16 v83, v57, v57, v83
  v_dot2_f32_bf16 v80, v58, v84, v80
  v_dot2_f32_bf16 v82, v58, v58, v82
  v_dot2_f32_bf16 v81, v59, v84, v81
  v_dot2_f32_bf16 v83, v59, v59, v83
  s_waitcnt vmcnt(3)
  v_dot2_f32_bf16 v80, v60, v84, v80
  v_dot2_f32_bf16 v82, v60, v60, v82
  v_dot2_f32_bf16 v81, v61, v84, v81
  v_dot2_f32_bf16 v83, v61, v61, v83
  v_dot2_f32_bf16 v80, v62, v84, v80
  v_dot2_f32_bf16 v82, v62, v62, v82
  v_dot2_f32_bf16 v81, v63, v84, v81
  v_dot2_f32_bf16 v83, v63, v63, v83
  s_waitcnt vmcnt(2)
  v_dot2_f32_bf16 v80, v64, v84, v80
  v_dot2_f32_bf16 v82, v64, v64, v82
  v_dot2_f32_bf16 v81, v65, v84, v81
  v_dot2_f32_bf16 v83, v65, v65, v83
  v_dot2_f32_bf16 v80, v66, v84, v80
  v_dot2_f32_bf16 v82, v66, v66, v82
  v_dot2_f32_bf16 v81, v67, v84, v81
  v_dot2_f32_bf16 v83, v67, v67, v83
  s_waitcnt vmcnt(1)
  v_dot2_f32_bf16 v80, v68, v84, v80
  v_dot2_f32_bf16 v82, v68, v68, v82
  v_dot2_f32_bf16 v81, v69, v84, v81
  v_dot2_f32_bf16 v83, v69, v69, v83
  v_dot2_f32_bf16 v80, v70, v84, v80
  v_dot2_f32_bf16 v82, v70, v70, v82
  v_dot2_f32_bf16 v81, v71, v84, v81
  v_dot2_f32_bf16 v83, v71, v71, v83
  s_waitcnt vmcnt(0)
  v_dot2_f32_bf16 v80, v72, v84, v80
  v_dot2_f32_bf16 v82, v72, v72, v82
  v_dot2_f32_bf16 v81, v73, v84, v81
  v_dot2_f32_bf16 v83, v73, v73, v83
  v_dot2_f32_bf16 v80, v74, v84, v80
  v_dot2_f32_bf16 v82, v74, v74, v82
  v_dot2_f32_bf16 v81, v75, v84, v81
  v_dot2_f32_bf16 v83, v75, v75, v83
  s_nop 1
  v_add_f32 v80, v80, v81
  v_add_f32 v82, v82, v83
  s_nop 0
  v_add_f32_dpp v80, v80, v80 quad_perm:[1,0,3,2] row_mask:0xf bank_mask:0xf
  v_add_f32_dpp v82, v82, v82 quad_perm:[1,0,3,2] row_mask:0xf bank_mask:0xf
  s_nop 0
  v_add_f32_dpp v80, v80, v80 quad_perm:[2,3,0,1] row_mask:0xf bank_mask:0xf
  v_add_f32_dpp v82, v82, v82 quad_perm:[2,3,0,1] row_mask:0xf bank_mask:0xf
  v_mul_f32 v80, 0.002232142857142857, v80
  v_mul_f32 v82, 0.002232142857142857, v82
  v_fma_f32 v82, -v80, v80, v82
  v_max_f32 v82, 0, v82
  v_add_f32 v82, 0x3727c5ac, v82
  v_rsq_f32 v88, v82
  s_nop 0
  v_mul_f32 v80, v80, v88
  v_sub_f32 v80, 0, v80
  v_mov_b32_dpp v89, v88 row_shl:4 row_mask:0xf bank_mask:0xf
  s_nop 0
  v_mov_b32_dpp v81, v80 row_shl:4 row_mask:0xf bank_mask:0xf
  v_cvt_pk_bf16_f32 v90, v80, v81
  v_mov_b32 v91, s72
  v_and_b32 v11, 7, v0
  v_cmp_eq_u32 vcc, 0, v11
  s_and_saveexec_b64 s[92:93], vcc
  buffer_store_dwordx4 v[88:91], v17, s[56:59], 0 offen sc1
  s_mov_b64 exec, s[92:93]
  s_cmp_lg_u32 s73, 0
  s_cbranch_scc1 LhMx
  s_mul_i32 s85, s75, 7168
  s_add_u32 s85, s85, 69248
  s_mov_b32 s84, 200000
LhM:
  buffer_load_dword v12, off, s[56:59], s85 sc1
  s_sub_u32 s84, s84, 1
  s_cbranch_scc1 LhMx
  s_waitcnt vmcnt(0)
  v_cmp_ne_u32 vcc, s72, v12
  s_cbranch_vccnz LhM
LhMx:
  s_barrier
  s_and_b32 s85, s75, 1
  s_lshl_b32 s85, s85, 2
  s_bfe_u32 s86, s75, 0x20001
  s_add_u32 s85, s85, s86
  s_cmp_eq_u32 s85, 7
  s_cbranch_scc1 LhCx
  s_lshl_b32 s85, s85, 2
  s_lshr_b32 s86, s75, 3
  s_add_u32 s87, s85, s86
  s_lshl_b32 s83, s87, 7
  v_lshrrev_b32 v11, 3, v0
  v_and_b32 v12, 7, v0
  v_mul_u32_u24 v13, 3584, v11
  v_lshl_add_u32 v13, v12, 4, v13
  v_lshlrev_b32 v11, 8, v11
  v_lshl_add_u32 v11, v12, 5, v11
  s_mov_b32 s85, 0x3f80
  s_mov_b32 s86, 0x3f800000
  buffer_load_dwordx4 v[20:23], v13, s[48:51], s83 offen
  s_add_u32 s83, s83, 114688
  buffer_load_dwordx4 v[24:27], v13, s[48:51], s83 offen
  s_add_u32 s83, s83, 114688
  buffer_load_dwordx4 v[28:31], v13, s[48:51], s83 offen
  s_add_u32 s83, s83, 114688
  buffer_load_dwordx4 v[32:35], v13, s[48:51], s83 offen
  s_add_u32 s83, s83, 114688
  buffer_load_dwordx4 v[36:39], v13, s[48:51], s83 offen
  s_add_u32 s83, s83, 114688
  buffer_load_dwordx4 v[40:43], v13, s[48:51], s83 offen
  s_add_u32 s83, s83, 114688
  buffer_load_dwordx4 v[44:47], v13, s[48:51], s83 offen
  s_add_u32 s83, s83, 114688
  buffer_load_dwordx4 v[48:51], v13, s[48:51], s83 offen
  s_add_u32 s83, s83, 114688
  buffer_load_dwordx4 v[52:55], v13, s[48:51], s83 offen
  s_add_u32 s83, s83, 114688
  buffer_load_dwordx4 v[56:59], v13, s[48:51], s83 offen
  s_add_u32 s83, s83, 114688
  buffer_load_dwordx4 v[60:63], v13, s[48:51], s83 offen
  s_add_u32 s83, s83, 114688
  buffer_load_dwordx4 v[64:67], v13, s[48:51], s83 offen
  s_add_u32 s83, s83, 114688
  buffer_load_dwordx4 v[68:71], v13, s[48:51], s83 offen
  s_add_u32 s83, s83, 114688
  buffer_load_dwordx4 v[72:75], v13, s[48:51], s83 offen
  s_add_u32 s83, s83, 114688
  s_waitcnt vmcnt(13)
  v_dot2_f32_bf16 v80, v20, s85, 0
  v_dot2_f32_bf16 v81, v20, s86, 0
  v_dot2_f32_bf16 v82, v21, s85, 0
  v_dot2_f32_bf16 v83, v21, s86, 0
  v_dot2_f32_bf16 v84, v22, s85, 0
  v_dot2_f32_bf16 v85, v22, s86, 0
  v_dot2_f32_bf16 v86, v23, s85, 0
  v_dot2_f32_bf16 v87, v23, s86, 0
  s_waitcnt vmcnt(12)
  v_dot2_f32_bf16 v80, v24, s85, v80
  v_dot2_f32_bf16 v81, v24, s86, v81
  v_dot2_f32_bf16 v82, v25, s85, v82
  v_dot2_f32_bf16 v83, v25, s86, v83
  v_dot2_f32_bf16 v84, v26, s85, v84
  v_dot2_f32_bf16 v85, v26, s86, v85
  v_dot2_f32_bf16 v86, v27, s85, v86
  v_dot2_f32_bf16 v87, v27, s86, v87
  s_waitcnt vmcnt(11)
  v_dot2_f32_bf16 v80, v28, s85, v80
  v_dot2_f32_bf16 v81, v28, s86, v81
  v_dot2_f32_bf16 v82, v29, s85, v82
  v_dot2_f32_bf16 v83, v29, s86, v83
  v_dot2_f32_bf16 v84, v30, s85, v84
  v_dot2_f32_bf16 v85, v30, s86, v85
  v_dot2_f32_bf16 v86, v31, s85, v86
  v_dot2_f32_bf16 v87, v31, s86, v87
  s_waitcnt vmcnt(10)
  v_dot2_f32_bf16 v80, v32, s85, v80
  v_dot2_f32_bf16 v81, v32, s86, v81
  v_dot2_f32_bf16 v82, v33, s85, v82
  v_dot2_f32_bf16 v83, v33, s86, v83
  v_dot2_f32_bf16 v84, v34, s85, v84
  v_dot2_f32_bf16 v85, v34, s86, v85
  v_dot2_f32_bf16 v86, v35, s85, v86
  v_dot2_f32_bf16 v87, v35, s86, v87
  s_waitcnt vmcnt(9)
  v_dot2_f32_bf16 v80, v36, s85, v80
  v_dot2_f32_bf16 v81, v36, s86, v81
  v_dot2_f32_bf16 v82, v37, s85, v82
  v_dot2_f32_bf16 v83, v37, s86, v83
  v_dot2_f32_bf16 v84, v38, s85, v84
  v_dot2_f32_bf16 v85, v38, s86, v85
  v_dot2_f32_bf16 v86, v39, s85, v86
  v_dot2_f32_bf16 v87, v39, s86, v87
  s_waitcnt vmcnt(8)
  v_dot2_f32_bf16 v80, v40, s85, v80
  v_dot2_f32_bf16 v81, v40, s86, v81
  v_dot2_f32_bf16 v82, v41, s85, v82
  v_dot2_f32_bf16 v83, v41, s86, v83
  v_dot2_f32_bf16 v84, v42, s85, v84
  v_dot2_f32_bf16 v85, v42, s86, v85
  v_dot2_f32_bf16 v86, v43, s85, v86
  v_dot2_f32_bf16 v87, v43, s86, v87
  s_waitcnt vmcnt(7)
  v_dot2_f32_bf16 v80, v44, s85, v80
  v_dot2_f32_bf16 v81, v44, s86, v81
  v_dot2_f32_bf16 v82, v45, s85, v82
  v_dot2_f32_bf16 v83, v45, s86, v83
  v_dot2_f32_bf16 v84, v46, s85, v84
  v_dot2_f32_bf16 v85, v46, s86, v85
  v_dot2_f32_bf16 v86, v47, s85, v86
  v_dot2_f32_bf16 v87, v47, s86, v87
  s_waitcnt vmcnt(6)
  v_dot2_f32_bf16 v80, v48, s85, v80
  v_dot2_f32_bf16 v81, v48, s86, v81
  v_dot2_f32_bf16 v82, v49, s85, v82
  v_dot2_f32_bf16 v83, v49, s86, v83
  v_dot2_f32_bf16 v84, v50, s85, v84
  v_dot2_f32_bf16 v85, v50, s86, v85
  v_dot2_f32_bf16 v86, v51, s85, v86
  v_dot2_f32_bf16 v87, v51, s86, v87
  s_waitcnt vmcnt(5)
  v_dot2_f32_bf16 v80, v52, s85, v80
  v_dot2_f32_bf16 v81, v52, s86, v81
  v_dot2_f32_bf16 v82, v53, s85, v82
  v_dot2_f32_bf16 v83, v53, s86, v83
  v_dot2_f32_bf16 v84, v54, s85, v84
  v_dot2_f32_bf16 v85, v54, s86, v85
  v_dot2_f32_bf16 v86, v55, s85, v86
  v_dot2_f32_bf16 v87, v55, s86, v87
  s_waitcnt vmcnt(4)
  v_dot2_f32_bf16 v80, v56, s85, v80
  v_dot2_f32_bf16 v81, v56, s86, v81
  v_dot2_f32_bf16 v82, v57, s85, v82
  v_dot2_f32_bf16 v83, v57, s86, v83
  v_dot2_f32_bf16 v84, v58, s85, v84
  v_dot2_f32_bf16 v85, v58, s86, v85
  v_dot2_f32_bf16 v86, v59, s85, v86
  v_dot2_f32_bf16 v87, v59, s86, v87
  s_waitcnt vmcnt(3)
  v_dot2_f32_bf16 v80, v60, s85, v80
  v_dot2_f32_bf16 v81, v60, s86, v81
  v_dot2_f32_bf16 v82, v61, s85, v82
  v_dot2_f32_bf16 v83, v61, s86, v83
  v_dot2_f32_bf16 v84, v62, s85, v84
  v_dot2_f32_bf16 v85, v62, s86, v85
  v_dot2_f32_bf16 v86, v63, s85, v86
  v_dot2_f32_bf16 v87, v63, s86, v87
  s_waitcnt vmcnt(2)
  v_dot2_f32_bf16 v80, v64, s85, v80
  v_dot2_f32_bf16 v81, v64, s86, v81
  v_dot2_f32_bf16 v82, v65, s85, v82
  v_dot2_f32_bf16 v83, v65, s86, v83
  v_dot2_f32_bf16 v84, v66, s85, v84
  v_dot2_f32_bf16 v85, v66, s86, v85
  v_dot2_f32_bf16 v86, v67, s85, v86
  v_dot2_f32_bf16 v87, v67, s86, v87
  s_waitcnt vmcnt(1)
  v_dot2_f32_bf16 v80, v68, s85, v80
  v_dot2_f32_bf16 v81, v68, s86, v81
  v_dot2_f32_bf16 v82, v69, s85, v82
  v_dot2_f32_bf16 v83, v69, s86, v83
  v_dot2_f32_bf16 v84, v70, s85, v84
  v_dot2_f32_bf16 v85, v70, s86, v85
  v_dot2_f32_bf16 v86, v71, s85, v86
  v_dot2_f32_bf16 v87, v71, s86, v87
  s_waitcnt vmcnt(0)
  v_dot2_f32_bf16 v80, v72, s85, v80
  v_dot2_f32_bf16 v81, v72, s86, v81
  v_dot2_f32_bf16 v82, v73, s85, v82
  v_dot2_f32_bf16 v83, v73, s86, v83
  v_dot2_f32_bf16 v84, v74, s85, v84
  v_dot2_f32_bf16 v85, v74, s86, v85
  v_dot2_f32_bf16 v86, v75, s85, v86
  v_dot2_f32_bf16 v87, v75, s86, v87
  ds_write_b128 v11, v[80:83]
  s_nop 1
  ds_write_b128 v11, v[84:87] offset:16
  s_waitcnt lgkmcnt(0)
  s_barrier
  s_cmp_lg_u32 s73, 0
  s_cbranch_scc1 LhCx
  v_lshlrev_b32 v11, 2, v1
  ds_read2st64_b32 v[20:21], v11 offset0:0 offset1:1
  ds_read2st64_b32 v[22:23], v11 offset0:2 offset1:3
  ds_read2st64_b32 v[24:25], v11 offset0:4 offset1:5
  ds_read2st64_b32 v[26:27], v11 offset0:6 offset1:7
  ds_read2st64_b32 v[28:29], v11 offset0:8 offset1:9
  ds_read2st64_b32 v[30:31], v11 offset0:10 offset1:11
  ds_read2st64_b32 v[32:33], v11 offset0:12 offset1:13
  ds_read2st64_b32 v[34:35], v11 offset0:14 offset1:15
  ds_read2st64_b32 v[36:37], v11 offset0:16 offset1:17
  ds_read2st64_b32 v[38:39], v11 offset0:18 offset1:19
  ds_read2st64_b32 v[40:41], v11 offset0:20 offset1:21
  ds_read2st64_b32 v[42:43], v11 offset0:22 offset1:23
  ds_read2st64_b32 v[44:45], v11 offset0:24 offset1:25
  ds_read2st64_b32 v[46:47], v11 offset0:26 offset1:27
  ds_read2st64_b32 v[48:49], v11 offset0:28 offset1:29
  ds_read2st64_b32 v[50:51], v11 offset0:30 offset1:31
  v_and_b32 v11, 19, v1
  v_bfe_u32 v12, v1, 2, 1
  v_lshl_or_b32 v11, v12, 3, v11
  v_bfe_u32 v12, v1, 3, 1
  v_lshl_or_b32 v11, v12, 2, v11
  v_lshlrev_b32 v11, 4, v11
  s_lshl_b32 s87, s87, 9
  s_add_u32 s87, s87, 360448
  s_waitcnt lgkmcnt(0)
  v_add_f32 v20, v20, v36
  v_add_f32 v21, v21, v37
  v_add_f32 v22, v22, v38
  v_add_f32 v23, v23, v39
  v_add_f32 v24, v24, v40
  v_add_f32 v25, v25, v41
  v_add_f32 v26, v26, v42
  v_add_f32 v27, v27, v43
  v_add_f32 v28, v28, v44
  v_add_f32 v29, v29, v45
  v_add_f32 v30, v30, v46
  v_add_f32 v31, v31, v47
  v_add_f32 v32, v32, v48
  v_add_f32 v33, v33, v49
  v_add_f32 v34, v34, v50
  v_add_f32 v35, v35, v51
  v_add_f32 v20, v20, v28
  v_add_f32 v21, v21, v29
  v_add_f32 v22, v22, v30
  v_add_f32 v23, v23, v31
  v_add_f32 v24, v24, v32
  v_add_f32 v25, v25, v33
  v_add_f32 v26, v26, v34
  v_add_f32 v27, v27, v35
  v_add_f32 v20, v20, v24
  v_add_f32 v21, v21, v25
  v_add_f32 v22, v22, v26
  v_add_f32 v23, v23, v27
  v_add_f32 v20, v20, v22
  v_add_f32 v21, v21, v23
  v_add_f32 v20, v20, v21
  v_mov_b32 v21, v20
  v_mov_b32 v22, s72
  v_mov_b32 v23, s72
  v_permlane32_swap_b32 v20, v21
  s_mov_b32 exec_hi, 0
  buffer_store_dwordx4 v[20:23], v11, s[56:59], s87 offen sc1
  s_mov_b32 exec_hi, -1
LhCx:
  s_cmp_lg_u32 s73, 1
  s_cbranch_scc1 Lhmx
  s_mul_i32 s85, s75, 7168
  s_add_u32 s85, s85, 69120
  s_mov_b32 s84, 200000
Lhm:
  buffer_load_dword v12, off, s[56:59], s85 sc1
  s_sub_u32 s84, s84, 1
  s_cbranch_scc1 Lhmx
  s_waitcnt vmcnt(0)
  v_cmp_ne_u32 vcc, s72, v12
  s_cbranch_vccnz Lhm
Lhmx:
  s_barrier
  s_mul_i32 s85, s75, 344064
  s_mul_i32 s86, s73, 43008
  s_add_u32 s85, s85, s86
  s_add_u32 s83, s85, 9437184
  buffer_store_dwordx4 v[92:95], v19, s[56:59], s83 offen offset:0 sc1
  buffer_store_dwordx4 v[92:95], v19, s[56:59], s83 offen offset:1024 sc1
  buffer_store_dwordx4 v[92:95], v19, s[56:59], s83 offen offset:2048 sc1
  buffer_store_dwordx4 v[92:95], v19, s[56:59], s83 offen offset:3072 sc1
  s_add_u32 s83, s83, 4096
  buffer_store_dwordx4 v[92:95], v19, s[56:59], s83 offen offset:0 sc1
  buffer_store_dwordx4 v[92:95], v19, s[56:59], s83 offen offset:1024 sc1
  buffer_store_dwordx4 v[92:95], v19, s[56:59], s83 offen offset:2048 sc1
  buffer_store_dwordx4 v[92:95], v19, s[56:59], s83 offen offset:3072 sc1
  s_add_u32 s83, s83, 4096
  buffer_store_dwordx4 v[92:95], v19, s[56:59], s83 offen offset:0 sc1
  buffer_store_dwordx4 v[92:95], v19, s[56:59], s83 offen offset:1024 sc1
  buffer_store_dwordx4 v[92:95], v19, s[56:59], s83 offen offset:2048 sc1
  buffer_store_dwordx4 v[92:95], v19, s[56:59], s83 offen offset:3072 sc1
  s_add_u32 s83, s83, 4096
  buffer_store_dwordx4 v[92:95], v19, s[56:59], s83 offen offset:0 sc1
  buffer_store_dwordx4 v[92:95], v19, s[56:59], s83 offen offset:1024 sc1
  buffer_store_dwordx4 v[92:95], v19, s[56:59], s83 offen offset:2048 sc1
  buffer_store_dwordx4 v[92:95], v19, s[56:59], s83 offen offset:3072 sc1
  s_add_u32 s83, s83, 4096
  buffer_store_dwordx4 v[92:95], v19, s[56:59], s83 offen offset:0 sc1
  buffer_store_dwordx4 v[92:95], v19, s[56:59], s83 offen offset:1024 sc1
  buffer_store_dwordx4 v[92:95], v19, s[56:59], s83 offen offset:2048 sc1
  buffer_store_dwordx4 v[92:95], v19, s[56:59], s83 offen offset:3072 sc1
  s_add_u32 s83, s83, 4096
  buffer_store_dwordx4 v[92:95], v19, s[56:59], s83 offen offset:0 sc1
  buffer_store_dwordx4 v[92:95], v19, s[56:59], s83 offen offset:1024 sc1
  buffer_store_dwordx4 v[92:95], v19, s[56:59], s83 offen offset:2048 sc1
  buffer_store_dwordx4 v[92:95], v19, s[56:59], s83 offen offset:3072 sc1
  s_add_u32 s83, s83, 4096
  buffer_store_dwordx4 v[92:95], v19, s[56:59], s83 offen offset:0 sc1
  buffer_store_dwordx4 v[92:95], v19, s[56:59], s83 offen offset:1024 sc1
  buffer_store_dwordx4 v[92:95], v19, s[56:59], s83 offen offset:2048 sc1
  buffer_store_dwordx4 v[92:95], v19, s[56:59], s83 offen offset:3072 sc1
  s_add_u32 s83, s83, 4096
  buffer_store_dwordx4 v[92:95], v19, s[56:59], s83 offen offset:0 sc1
  buffer_store_dwordx4 v[92:95], v19, s[56:59], s83 offen offset:1024 sc1
  buffer_store_dwordx4 v[92:95], v19, s[56:59], s83 offen offset:2048 sc1
  buffer_store_dwordx4 v[92:95], v19, s[56:59], s83 offen offset:3072 sc1
  s_add_u32 s83, s83, 4096
  buffer_store_dwordx4 v[92:95], v19, s[56:59], s83 offen offset:0 sc1
  buffer_store_dwordx4 v[92:95], v19, s[56:59], s83 offen offset:1024 sc1
  buffer_store_dwordx4 v[92:95], v19, s[56:59], s83 offen offset:2048 sc1
  buffer_store_dwordx4 v[92:95], v19, s[56:59], s83 offen offset:3072 sc1
  s_add_u32 s83, s83, 4096
  buffer_store_dwordx4 v[92:95], v19, s[56:59], s83 offen offset:0 sc1
  buffer_store_dwordx4 v[92:95], v19, s[56:59], s83 offen offset:1024 sc1
  buffer_store_dwordx4 v[92:95], v19, s[56:59], s83 offen offset:2048 sc1
  buffer_store_dwordx4 v[92:95], v19, s[56:59], s83 offen offset:3072 sc1
  s_add_u32 s83, s83, 4096
  buffer_store_dwordx4 v[92:95], v19, s[56:59], s83 offen offset:0 sc1
  buffer_store_dwordx4 v[92:95], v19, s[56:59], s83 offen offset:1024 sc1
  s_waitcnt vmcnt(0)
  s_barrier
  s_mul_i32 s85, s75, 7168
  s_add_u32 s85, s85, 65536
  v_mov_b32 v12, s85
  v_cmp_eq_u32 vcc, 0, v0
  s_and_saveexec_b64 s[92:93], vcc
  buffer_store_dword v92, v12, s[56:59], 0 offen sc1
  s_mov_b64 exec, s[92:93]
  s_waitcnt vmcnt(0)
  s_endpgm
Lend:
  s_endpgm
.section .rodata,"a"
.p2align 6
.amdhsa_kernel sequential_preLN__ssm_conv_h3__dense_activation_mish__prompt_kernel
  .amdhsa_next_free_vgpr 512
  .amdhsa_next_free_sgpr 102
  .amdhsa_accum_offset 256
  .amdhsa_group_segment_fixed_size 0
  .amdhsa_kernarg_size 104
  .amdhsa_user_sgpr_count 2
  .amdhsa_user_sgpr_kernarg_segment_ptr 1
  .amdhsa_system_sgpr_workgroup_id_x 1
.end_amdhsa_kernel
```
